```python
import torch

def _softmax(x, axis=-1):
    return torch.softmax(x, dim=axis)
def _gelu(x):
    return torch.nn.functional.gelu(x, approximate="tanh")
def _silu(x):
    return torch.nn.functional.silu(x)
def _sigmoid(x):
    return torch.sigmoid(x)
def _layernorm(x, axis=-1, eps=1e-5):
    m = x.mean(dim=axis, keepdim=True)
    v = x.var(dim=axis, keepdim=True, unbiased=False)
    return (x - m) / torch.sqrt(v + eps)
def _scatter_add(tgt, idx, src, axis=0):
    return tgt.clone().index_add_(axis, idx, src)
def _segment_sum(src, seg, n):
    out = torch.zeros((n,) + src.shape[1:], dtype=src.dtype)
    return out.index_add_(0, seg, src)
def _pad(x, pw):
    flat = tuple(v for pair in reversed(pw) for v in pair)
    return torch.nn.functional.pad(x, flat)

kernel_name = 'concat_heads__sliding_block_cached__compressed_kv_cla__decode'

def setup_inputs():

    _w = (lambda a: (lambda t: t.to(torch.bfloat16) if t.is_floating_point() else t)(torch.as_tensor(a)))
    def _A_setup():
        B, Sq, D = 4, 1, 512
        Hq, Hkv, Sk, Dh = 32, 8, 8192, 128
        assert Hq % Hkv == 0, (Hq, Hkv)
        return {
            "x": _w((lambda *s: torch.randn(*s, dtype=torch.bfloat16) * 1.6)(B, Sq, D)),
            "k_cache": _w((lambda *s: torch.randn(*s, dtype=torch.bfloat16) * 1.6)(B, Hkv, Sk, Dh)),
            "v_cache": _w((lambda *s: torch.randn(*s, dtype=torch.bfloat16) * 0.05)(B, Hkv, Sk, Dh)),
            "wq": _w((lambda *s: torch.randn(*s, dtype=torch.bfloat16) * 1.6)(D, Hq * Dh) * (D ** -0.5)),
            "wo": _w((lambda *s: torch.randn(*s, dtype=torch.bfloat16) * 0.05)(Hq * Dh, D) * ((Hq * Dh) ** -0.5)),
        }
    _A_in = _A_setup()

    def _B_setup():
        B, H, Sq, Sk, D, M = 4, 32, 1, 8192, 128, 512
        Dc = 4 * D
        return {
            "x": _w((lambda *s: torch.randn(*s, dtype=torch.bfloat16) * 3.2)(B, Sq, M)),
            "c_kv": _w((lambda *s: torch.randn(*s, dtype=torch.bfloat16) * 0.1)(B, Sk, Dc)),
            "w_q": _w((lambda *s: torch.randn(*s, dtype=torch.bfloat16) * 6.4)(M, H, D) * (M ** -0.5)),
            "w_uk": _w((lambda *s: torch.randn(*s, dtype=torch.bfloat16) * 6.4)(Dc, H, D) * (Dc ** -0.5)),
            "w_uv": _w((lambda *s: torch.randn(*s, dtype=torch.bfloat16) * 0.1)(Dc, H, D) * (Dc ** -0.5)),
            "w_o": _w((lambda *s: torch.randn(*s, dtype=torch.bfloat16) * 0.1)(H, D, M) * ((H * D) ** -0.5)),
        }
    _B_in = _B_setup()

    return {
        "A_x": _A_in["x"],
        "A_k_cache": _A_in["k_cache"],
        "A_v_cache": _A_in["v_cache"],
        "A_wq": _A_in["wq"],
        "A_wo": _A_in["wo"],
        "B_x": _B_in["x"],
        "B_c_kv": _B_in["c_kv"],
        "B_w_q": _B_in["w_q"],
        "B_w_uk": _B_in["w_uk"],
        "B_w_uv": _B_in["w_uv"],
        "B_w_o": _B_in["w_o"],
    }

def reference(A_x, A_k_cache, A_v_cache, A_wq, A_wo, B_x, B_c_kv, B_w_q, B_w_uk, B_w_uv, B_w_o):
    def _A_ref(x, k_cache, v_cache, wq, wo):
        B, Sq, D = x.shape
        Hq, Dh = 32, 128
        Hkv, Sk = k_cache.shape[1], k_cache.shape[2]
        W = min(4096, max(256, Sk // 4))
        rep = Hq // Hkv
        q = (lambda x, *d: x.permute(*d))((x @ wq).reshape(B, Sq, Hq, Dh), 0, 2, 1, 3)
        k = (lambda x, n, axis: torch.repeat_interleave(x, n, dim=axis))(k_cache[:, :, Sk - W:, :], rep, axis=1)
        v = (lambda x, n, axis: torch.repeat_interleave(x, n, dim=axis))(v_cache[:, :, Sk - W:, :], rep, axis=1)
        scores = torch.einsum("bhqd,bhkd->bhqk", q, k) * (Dh ** -0.5)
        p = _softmax(scores, axis=-1)
        o = torch.einsum("bhqk,bhkd->bhqd", p, v)
        return (lambda x, *d: x.permute(*d))(o, 0, 2, 1, 3).reshape(B, Sq, Hq * Dh) @ wo

    def _B_ref(x, c_kv, w_q, w_uk, w_uv, w_o):
        B, Sq, M = x.shape[0], x.shape[1], x.shape[2]
        Sk = c_kv.shape[1]
        H, D = w_q.shape[1], w_q.shape[2]
        q = torch.einsum("bqm,mhd->bhqd", x, w_q)
        k = torch.einsum("bkc,chd->bhkd", c_kv, w_uk)
        v = torch.einsum("bkc,chd->bhkd", c_kv, w_uv)
        scores = torch.einsum("bhqd,bhkd->bhqk", q, k) * (D ** -0.5)
        off = Sk - Sq
        qi = torch.arange(Sq)[:, None]
        kj = torch.arange(Sk)[None, :]
        cmask = kj <= (qi + off)
        scores = torch.where(cmask[None, None], scores, -1e9)
        p = _softmax(scores, axis=-1)
        ctx = torch.einsum("bhqk,bhkd->bhqd", p, v)
        return torch.einsum("bhqd,hdm->bqm", ctx, w_o)

    a = _A_ref(A_x, A_k_cache, A_v_cache, A_wq, A_wo)
    b = _B_ref(B_x, B_c_kv, B_w_q, B_w_uk, B_w_uv, B_w_o)
    return torch.concatenate([a, b], axis=-1)
```

```asm
; @launch kernel=k1_kernel grid=(64,1,1) block=(1024,1,1) lds=36864
; @launch kernel=k2_kernel grid=(256,1,1) block=(256,1,1) lds=134144
; @launch kernel=k3_kernel grid=(256,1,1) block=(256,1,1) lds=10240
; @launch kernel=k4_kernel grid=(40,1,1) block=(256,1,1) lds=1024
.amdgcn_target "amdgcn-amd-amdhsa--gfx950"
.text
.globl k1_kernel
.globl k2_kernel
.globl k3_kernel
.globl k4_kernel
.p2align 8
.type k1_kernel,@function
k1_kernel:
    s_cmp_ge_u32 s2, 64
    s_cbranch_scc1 Lk1_end
    s_and_b32 s3, s2, 31
    s_lshr_b32 s28, s2, 5
    s_load_dwordx2 s[10:11], s[0:1], 104
    s_load_dwordx2 s[8:9], s[0:1], 64
    s_cmp_eq_u32 s28, 0
    s_cbranch_scc1 Lk1_a
    s_load_dwordx2 s[4:5], s[0:1], 40
    s_load_dwordx2 s[6:7], s[0:1], 56
    s_branch Lk1_go
Lk1_a:
    s_load_dwordx2 s[4:5], s[0:1], 0
    s_load_dwordx2 s[6:7], s[0:1], 24
Lk1_go:
    v_and_b32 v1, 63, v0
    v_lshrrev_b32 v2, 4, v1
    v_and_b32 v3, 15, v1
    v_lshrrev_b32 v4, 6, v0
    s_nop 0
    v_readfirstlane_b32 s29, v4
    s_mov_b32 s30, 0x05040100
    s_mov_b32 s31, 0x07060302
    s_waitcnt lgkmcnt(0)
    s_mov_b32 s12, s4
    s_mov_b32 s13, s5
    s_mov_b32 s14, 0x1000
    s_mov_b32 s15, 0x00020000
    s_mov_b32 s16, s6
    s_mov_b32 s17, s7
    s_mov_b32 s18, 0x400000
    s_mov_b32 s19, 0x00020000
    s_mov_b32 s20, s8
    s_mov_b32 s21, s9
    s_mov_b32 s22, 0x400000
    s_mov_b32 s23, 0x00020000
    s_mov_b32 s24, s10
    s_mov_b32 s25, s11
    s_mov_b32 s26, 0x10000000
    s_mov_b32 s27, 0x00020000
    v_lshlrev_b32 v5, 16, v2
    v_lshl_add_u32 v5, v3, 4, v5
    s_lshl_b32 s32, s29, 18
    s_lshl_b32 s33, s3, 8
    s_add_u32 s32, s32, s33
    s_add_u32 s34, s32, 0
    buffer_load_dwordx4 v[8:11], v5, s[16:19], s34 offen nt
    s_add_u32 s34, s32, 8192
    buffer_load_dwordx4 v[12:15], v5, s[16:19], s34 offen nt
    s_add_u32 s34, s32, 16384
    buffer_load_dwordx4 v[16:19], v5, s[16:19], s34 offen nt
    s_add_u32 s34, s32, 24576
    buffer_load_dwordx4 v[20:23], v5, s[16:19], s34 offen nt
    s_add_u32 s34, s32, 32768
    buffer_load_dwordx4 v[24:27], v5, s[16:19], s34 offen nt
    s_add_u32 s34, s32, 40960
    buffer_load_dwordx4 v[28:31], v5, s[16:19], s34 offen nt
    s_add_u32 s34, s32, 49152
    buffer_load_dwordx4 v[32:35], v5, s[16:19], s34 offen nt
    s_add_u32 s34, s32, 57344
    buffer_load_dwordx4 v[36:39], v5, s[16:19], s34 offen nt
    v_lshlrev_b32 v6, 10, v3
    v_lshl_add_u32 v6, v2, 4, v6
    s_lshl_b32 s34, s29, 6
    buffer_load_dwordx4 v[4:7], v6, s[12:15], s34 offen
    s_cmp_eq_u32 s28, 0
    s_cbranch_scc1 Lk1_nou
    v_lshlrev_b32 v112, 13, v3
    v_lshl_add_u32 v112, v2, 4, v112
    s_add_u32 s34, s32, 0
    buffer_load_dwordx4 v[40:43], v112, s[20:23], s34 offen offset:0 nt
    buffer_load_dwordx4 v[44:47], v112, s[20:23], s34 offen offset:64 nt
    buffer_load_dwordx4 v[48:51], v112, s[20:23], s34 offen offset:128 nt
    buffer_load_dwordx4 v[52:55], v112, s[20:23], s34 offen offset:192 nt
    s_add_u32 s34, s32, 131072
    buffer_load_dwordx4 v[56:59], v112, s[20:23], s34 offen offset:0 nt
    buffer_load_dwordx4 v[60:63], v112, s[20:23], s34 offen offset:64 nt
    buffer_load_dwordx4 v[64:67], v112, s[20:23], s34 offen offset:128 nt
    buffer_load_dwordx4 v[68:71], v112, s[20:23], s34 offen offset:192 nt
    s_waitcnt vmcnt(8)
    s_branch Lk1_mm
Lk1_nou:
    s_waitcnt vmcnt(0)
Lk1_mm:
    v_perm_b32 v72, v12, v8, s30
    v_perm_b32 v73, v20, v16, s30
    v_perm_b32 v74, v28, v24, s30
    v_perm_b32 v75, v36, v32, s30
    s_nop 1
    v_mfma_f32_16x16x32_bf16 v[80:83], v[72:75], v[4:7], 0
    v_perm_b32 v76, v12, v8, s31
    v_perm_b32 v77, v20, v16, s31
    v_perm_b32 v78, v28, v24, s31
    v_perm_b32 v79, v36, v32, s31
    s_nop 1
    v_mfma_f32_16x16x32_bf16 v[84:87], v[76:79], v[4:7], 0
    v_perm_b32 v72, v13, v9, s30
    v_perm_b32 v73, v21, v17, s30
    v_perm_b32 v74, v29, v25, s30
    v_perm_b32 v75, v37, v33, s30
    s_nop 1
    v_mfma_f32_16x16x32_bf16 v[88:91], v[72:75], v[4:7], 0
    v_perm_b32 v76, v13, v9, s31
    v_perm_b32 v77, v21, v17, s31
    v_perm_b32 v78, v29, v25, s31
    v_perm_b32 v79, v37, v33, s31
    s_nop 1
    v_mfma_f32_16x16x32_bf16 v[92:95], v[76:79], v[4:7], 0
    v_perm_b32 v72, v14, v10, s30
    v_perm_b32 v73, v22, v18, s30
    v_perm_b32 v74, v30, v26, s30
    v_perm_b32 v75, v38, v34, s30
    s_nop 1
    v_mfma_f32_16x16x32_bf16 v[96:99], v[72:75], v[4:7], 0
    v_perm_b32 v76, v14, v10, s31
    v_perm_b32 v77, v22, v18, s31
    v_perm_b32 v78, v30, v26, s31
    v_perm_b32 v79, v38, v34, s31
    s_nop 1
    v_mfma_f32_16x16x32_bf16 v[100:103], v[76:79], v[4:7], 0
    v_perm_b32 v72, v15, v11, s30
    v_perm_b32 v73, v23, v19, s30
    v_perm_b32 v74, v31, v27, s30
    v_perm_b32 v75, v39, v35, s30
    s_nop 1
    v_mfma_f32_16x16x32_bf16 v[104:107], v[72:75], v[4:7], 0
    v_perm_b32 v76, v15, v11, s31
    v_perm_b32 v77, v23, v19, s31
    v_perm_b32 v78, v31, v27, s31
    v_perm_b32 v79, v39, v35, s31
    s_nop 1
    v_mfma_f32_16x16x32_bf16 v[108:111], v[76:79], v[4:7], 0
    s_nop 7
    s_nop 3
    v_cmp_gt_u32 vcc, 4, v3
    s_lshl_b32 s34, s29, 11
    v_lshlrev_b32 v113, 9, v3
    v_lshl_add_u32 v113, v2, 7, v113
    v_add_u32 v113, s34, v113
    s_and_saveexec_b64 s[36:37], vcc
    ds_write_b128 v113, v[80:83] offset:0
    ds_write_b128 v113, v[84:87] offset:16
    ds_write_b128 v113, v[88:91] offset:32
    ds_write_b128 v113, v[92:95] offset:48
    ds_write_b128 v113, v[96:99] offset:64
    ds_write_b128 v113, v[100:103] offset:80
    ds_write_b128 v113, v[104:107] offset:96
    ds_write_b128 v113, v[108:111] offset:112
    s_mov_b64 exec, s[36:37]
    s_waitcnt lgkmcnt(0)
    s_barrier
    v_cmp_gt_u32 vcc, 512, v0
    s_and_saveexec_b64 s[36:37], vcc
    s_cbranch_execz Lk1_red_done
    v_lshlrev_b32 v114, 2, v0
    ds_read_b32 v8, v114 offset:0
    ds_read_b32 v9, v114 offset:2048
    ds_read_b32 v10, v114 offset:4096
    ds_read_b32 v11, v114 offset:6144
    ds_read_b32 v12, v114 offset:8192
    ds_read_b32 v13, v114 offset:10240
    ds_read_b32 v14, v114 offset:12288
    ds_read_b32 v15, v114 offset:14336
    ds_read_b32 v16, v114 offset:16384
    ds_read_b32 v17, v114 offset:18432
    ds_read_b32 v18, v114 offset:20480
    ds_read_b32 v19, v114 offset:22528
    ds_read_b32 v20, v114 offset:24576
    ds_read_b32 v21, v114 offset:26624
    ds_read_b32 v22, v114 offset:28672
    ds_read_b32 v23, v114 offset:30720
    s_waitcnt lgkmcnt(0)
    v_add_f32 v8, v8, v9
    v_add_f32 v8, v8, v10
    v_add_f32 v8, v8, v11
    v_add_f32 v8, v8, v12
    v_add_f32 v8, v8, v13
    v_add_f32 v8, v8, v14
    v_add_f32 v8, v8, v15
    v_add_f32 v8, v8, v16
    v_add_f32 v8, v8, v17
    v_add_f32 v8, v8, v18
    v_add_f32 v8, v8, v19
    v_add_f32 v8, v8, v20
    v_add_f32 v8, v8, v21
    v_add_f32 v8, v8, v22
    v_add_f32 v8, v8, v23
    v_cvt_pk_bf16_f32 v8, v8, v8
    v_lshrrev_b32 v9, 7, v0
    v_bfe_u32 v10, v0, 5, 2
    v_bfe_u32 v11, v0, 2, 3
    v_and_b32 v12, 3, v0
    v_lshlrev_b32 v10, 5, v10
    v_lshl_add_u32 v10, v12, 3, v10
    v_add_u32 v10, v10, v11
    s_cmp_eq_u32 s28, 0
    s_cbranch_scc0 Lk1_red_b
    v_lshlrev_b32 v9, 12, v9
    v_add_u32 v10, v10, v9
    v_lshlrev_b32 v10, 1, v10
    s_lshl_b32 s34, s3, 8
    buffer_store_short v8, v10, s[24:27], s34 offen
    s_branch Lk1_red_done
Lk1_red_b:
    v_lshlrev_b32 v9, 7, v9
    v_add_u32 v10, v10, v9
    v_lshlrev_b32 v10, 1, v10
    ds_write_b16 v10, v8 offset:32768
Lk1_red_done:
    s_mov_b64 exec, s[36:37]
    s_cmp_eq_u32 s28, 0
    s_cbranch_scc1 Lk1_end
    s_waitcnt lgkmcnt(0)
    s_barrier
    v_mov_b32 v8, 0
    v_mov_b32 v9, 0
    v_mov_b32 v10, 0
    v_mov_b32 v11, 0
    v_mov_b32 v12, 0
    v_mov_b32 v13, 0
    v_mov_b32 v14, 0
    v_mov_b32 v15, 0
    v_mov_b32 v16, 0
    v_mov_b32 v17, 0
    v_mov_b32 v18, 0
    v_mov_b32 v19, 0
    v_mov_b32 v20, 0
    v_mov_b32 v21, 0
    v_mov_b32 v22, 0
    v_mov_b32 v23, 0
    v_cmp_gt_u32 vcc, 4, v3
    v_lshlrev_b32 v113, 8, v3
    v_lshl_add_u32 v113, v2, 4, v113
    s_and_saveexec_b64 s[36:37], vcc
    ds_read_b128 v[8:11], v113 offset:32768
    ds_read_b128 v[12:15], v113 offset:32832
    ds_read_b128 v[16:19], v113 offset:32896
    ds_read_b128 v[20:23], v113 offset:32960
    s_mov_b64 exec, s[36:37]
    s_waitcnt lgkmcnt(0) vmcnt(0)
    v_mfma_f32_16x16x32_bf16 v[80:83], v[40:43], v[8:11], 0
    v_mfma_f32_16x16x32_bf16 v[80:83], v[44:47], v[12:15], v[80:83]
    v_mfma_f32_16x16x32_bf16 v[80:83], v[48:51], v[16:19], v[80:83]
    v_mfma_f32_16x16x32_bf16 v[80:83], v[52:55], v[20:23], v[80:83]
    v_mfma_f32_16x16x32_bf16 v[84:87], v[56:59], v[8:11], 0
    v_mfma_f32_16x16x32_bf16 v[84:87], v[60:63], v[12:15], v[84:87]
    v_mfma_f32_16x16x32_bf16 v[84:87], v[64:67], v[16:19], v[84:87]
    v_mfma_f32_16x16x32_bf16 v[84:87], v[68:71], v[20:23], v[84:87]
    s_nop 7
    s_nop 3
    v_cvt_pk_bf16_f32 v88, v80, v81
    v_cvt_pk_bf16_f32 v89, v82, v83
    v_cvt_pk_bf16_f32 v90, v84, v85
    v_cvt_pk_bf16_f32 v91, v86, v87
    v_lshlrev_b32 v113, 15, v3
    v_lshl_add_u32 v113, v2, 3, v113
    s_lshl_b32 s34, s3, 10
    s_lshl_b32 s35, s29, 6
    s_add_u32 s34, s34, s35
    s_add_u32 s34, s34, 0x10000
    v_cmp_gt_u32 vcc, 4, v3
    s_and_saveexec_b64 s[36:37], vcc
    buffer_store_dwordx2 v[88:89], v113, s[24:27], s34 offen
    buffer_store_dwordx2 v[90:91], v113, s[24:27], s34 offen offset:32
    s_mov_b64 exec, s[36:37]
Lk1_end:
    s_endpgm
.p2align 8
.type k2_kernel,@function
k2_kernel:
    s_cmp_ge_u32 s2, 256
    s_cbranch_scc1 Lk2_end
    s_lshr_b32 s3, s2, 4
    s_lshl_b32 s3, s3, 3
    s_and_b32 s28, s2, 7
    s_or_b32 s3, s3, s28
    s_bfe_u32 s28, s2, 0x10003
    s_load_dwordx2 s[10:11], s[0:1], 104
    v_and_b32 v1, 63, v0
    v_lshrrev_b32 v2, 4, v1
    v_and_b32 v3, 15, v1
    v_lshrrev_b32 v4, 6, v0
    s_nop 0
    v_readfirstlane_b32 s29, v4
    s_mov_b32 s30, 0x05040100
    s_mov_b32 s31, 0x07060302
    s_mov_b32 s33, 0x3e0293ee
    s_cmp_eq_u32 s28, 1
    s_cbranch_scc1 Lk2_b
    s_load_dwordx2 s[4:5], s[0:1], 8
    s_load_dwordx2 s[6:7], s[0:1], 16
    s_waitcnt lgkmcnt(0)
    s_mov_b32 s12, s4
    s_mov_b32 s13, s5
    s_mov_b32 s14, 0x4000000
    s_mov_b32 s15, 0x00020000
    s_mov_b32 s16, s6
    s_mov_b32 s17, s7
    s_mov_b32 s18, 0x4000000
    s_mov_b32 s19, 0x00020000
    s_mov_b32 s24, s10
    s_mov_b32 s25, s11
    s_mov_b32 s26, 0x10000000
    s_mov_b32 s27, 0x00020000
    s_lshr_b32 s34, s3, 2
    s_and_b32 s35, s3, 3
    v_mov_b32 v16, 0
    v_mov_b32 v17, 0
    v_mov_b32 v18, 0
    v_mov_b32 v19, 0
    v_mov_b32 v20, 0
    v_mov_b32 v21, 0
    v_mov_b32 v22, 0
    v_mov_b32 v23, 0
    v_mov_b32 v24, 0
    v_mov_b32 v25, 0
    v_mov_b32 v26, 0
    v_mov_b32 v27, 0
    v_mov_b32 v28, 0
    v_mov_b32 v29, 0
    v_mov_b32 v30, 0
    v_mov_b32 v31, 0
    v_lshlrev_b32 v5, 8, v3
    v_lshl_add_u32 v5, v2, 4, v5
    s_lshl_b32 s36, s34, 10
    v_cmp_gt_u32 vcc, 4, v3
    s_and_saveexec_b64 s[40:41], vcc
    buffer_load_dwordx4 v[16:19], v5, s[24:27], s36 offen offset:0
    buffer_load_dwordx4 v[20:23], v5, s[24:27], s36 offen offset:64
    buffer_load_dwordx4 v[24:27], v5, s[24:27], s36 offen offset:128
    buffer_load_dwordx4 v[28:31], v5, s[24:27], s36 offen offset:192
    s_mov_b64 exec, s[40:41]
    s_lshl_b32 s37, s34, 21
    s_lshl_b32 s38, s35, 17
    s_add_u32 s37, s37, s38
    s_lshl_b32 s38, s29, 15
    s_add_u32 s37, s37, s38
    s_add_u32 s37, s37, 1572864
    s_add_u32 s38, s37, 0
    buffer_load_dwordx4 a[0:3], v5, s[12:15], s38 offen offset:0 nt
    buffer_load_dwordx4 a[4:7], v5, s[12:15], s38 offen offset:64 nt
    buffer_load_dwordx4 a[8:11], v5, s[12:15], s38 offen offset:128 nt
    buffer_load_dwordx4 a[12:15], v5, s[12:15], s38 offen offset:192 nt
    s_add_u32 s38, s37, 4096
    buffer_load_dwordx4 a[16:19], v5, s[12:15], s38 offen offset:0 nt
    buffer_load_dwordx4 a[20:23], v5, s[12:15], s38 offen offset:64 nt
    buffer_load_dwordx4 a[24:27], v5, s[12:15], s38 offen offset:128 nt
    buffer_load_dwordx4 a[28:31], v5, s[12:15], s38 offen offset:192 nt
    s_add_u32 s38, s37, 8192
    buffer_load_dwordx4 a[32:35], v5, s[12:15], s38 offen offset:0 nt
    buffer_load_dwordx4 a[36:39], v5, s[12:15], s38 offen offset:64 nt
    buffer_load_dwordx4 a[40:43], v5, s[12:15], s38 offen offset:128 nt
    buffer_load_dwordx4 a[44:47], v5, s[12:15], s38 offen offset:192 nt
    s_add_u32 s38, s37, 12288
    buffer_load_dwordx4 a[48:51], v5, s[12:15], s38 offen offset:0 nt
    buffer_load_dwordx4 a[52:55], v5, s[12:15], s38 offen offset:64 nt
    buffer_load_dwordx4 a[56:59], v5, s[12:15], s38 offen offset:128 nt
    buffer_load_dwordx4 a[60:63], v5, s[12:15], s38 offen offset:192 nt
    s_add_u32 s38, s37, 16384
    buffer_load_dwordx4 a[64:67], v5, s[12:15], s38 offen offset:0 nt
    buffer_load_dwordx4 a[68:71], v5, s[12:15], s38 offen offset:64 nt
    buffer_load_dwordx4 a[72:75], v5, s[12:15], s38 offen offset:128 nt
    buffer_load_dwordx4 a[76:79], v5, s[12:15], s38 offen offset:192 nt
    s_add_u32 s38, s37, 20480
    buffer_load_dwordx4 a[80:83], v5, s[12:15], s38 offen offset:0 nt
    buffer_load_dwordx4 a[84:87], v5, s[12:15], s38 offen offset:64 nt
    buffer_load_dwordx4 a[88:91], v5, s[12:15], s38 offen offset:128 nt
    buffer_load_dwordx4 a[92:95], v5, s[12:15], s38 offen offset:192 nt
    s_add_u32 s38, s37, 24576
    buffer_load_dwordx4 a[96:99], v5, s[12:15], s38 offen offset:0 nt
    buffer_load_dwordx4 a[100:103], v5, s[12:15], s38 offen offset:64 nt
    buffer_load_dwordx4 a[104:107], v5, s[12:15], s38 offen offset:128 nt
    buffer_load_dwordx4 a[108:111], v5, s[12:15], s38 offen offset:192 nt
    s_add_u32 s38, s37, 28672
    buffer_load_dwordx4 a[112:115], v5, s[12:15], s38 offen offset:0 nt
    buffer_load_dwordx4 a[116:119], v5, s[12:15], s38 offen offset:64 nt
    buffer_load_dwordx4 a[120:123], v5, s[12:15], s38 offen offset:128 nt
    buffer_load_dwordx4 a[124:127], v5, s[12:15], s38 offen offset:192 nt
    v_lshlrev_b32 v6, 10, v2
    v_lshl_add_u32 v6, v3, 4, v6
    s_add_u32 s38, s37, 0
    buffer_load_dwordx4 v[128:131], v6, s[16:19], s38 offen offset:0 nt
    buffer_load_dwordx4 v[132:135], v6, s[16:19], s38 offen offset:256 nt
    buffer_load_dwordx4 v[136:139], v6, s[16:19], s38 offen offset:512 nt
    buffer_load_dwordx4 v[140:143], v6, s[16:19], s38 offen offset:768 nt
    s_add_u32 s38, s37, 4096
    buffer_load_dwordx4 v[144:147], v6, s[16:19], s38 offen offset:0 nt
    buffer_load_dwordx4 v[148:151], v6, s[16:19], s38 offen offset:256 nt
    buffer_load_dwordx4 v[152:155], v6, s[16:19], s38 offen offset:512 nt
    buffer_load_dwordx4 v[156:159], v6, s[16:19], s38 offen offset:768 nt
    s_add_u32 s38, s37, 8192
    buffer_load_dwordx4 v[160:163], v6, s[16:19], s38 offen offset:0 nt
    buffer_load_dwordx4 v[164:167], v6, s[16:19], s38 offen offset:256 nt
    buffer_load_dwordx4 v[168:171], v6, s[16:19], s38 offen offset:512 nt
    buffer_load_dwordx4 v[172:175], v6, s[16:19], s38 offen offset:768 nt
    s_add_u32 s38, s37, 12288
    buffer_load_dwordx4 v[176:179], v6, s[16:19], s38 offen offset:0 nt
    buffer_load_dwordx4 v[180:183], v6, s[16:19], s38 offen offset:256 nt
    buffer_load_dwordx4 v[184:187], v6, s[16:19], s38 offen offset:512 nt
    buffer_load_dwordx4 v[188:191], v6, s[16:19], s38 offen offset:768 nt
    s_add_u32 s38, s37, 16384
    buffer_load_dwordx4 v[192:195], v6, s[16:19], s38 offen offset:0 nt
    buffer_load_dwordx4 v[196:199], v6, s[16:19], s38 offen offset:256 nt
    buffer_load_dwordx4 v[200:203], v6, s[16:19], s38 offen offset:512 nt
    buffer_load_dwordx4 v[204:207], v6, s[16:19], s38 offen offset:768 nt
    s_add_u32 s38, s37, 20480
    buffer_load_dwordx4 v[208:211], v6, s[16:19], s38 offen offset:0 nt
    buffer_load_dwordx4 v[212:215], v6, s[16:19], s38 offen offset:256 nt
    buffer_load_dwordx4 v[216:219], v6, s[16:19], s38 offen offset:512 nt
    buffer_load_dwordx4 v[220:223], v6, s[16:19], s38 offen offset:768 nt
    s_add_u32 s38, s37, 24576
    buffer_load_dwordx4 v[224:227], v6, s[16:19], s38 offen offset:0 nt
    buffer_load_dwordx4 v[228:231], v6, s[16:19], s38 offen offset:256 nt
    buffer_load_dwordx4 v[232:235], v6, s[16:19], s38 offen offset:512 nt
    buffer_load_dwordx4 v[236:239], v6, s[16:19], s38 offen offset:768 nt
    s_add_u32 s38, s37, 28672
    buffer_load_dwordx4 v[240:243], v6, s[16:19], s38 offen offset:0 nt
    buffer_load_dwordx4 v[244:247], v6, s[16:19], s38 offen offset:256 nt
    buffer_load_dwordx4 v[248:251], v6, s[16:19], s38 offen offset:512 nt
    buffer_load_dwordx4 v[252:255], v6, s[16:19], s38 offen offset:768 nt
    s_waitcnt vmcnt(32)
    v_mfma_f32_16x16x32_bf16 v[32:35], a[0:3], v[16:19], 0
    v_mfma_f32_16x16x32_bf16 v[32:35], a[4:7], v[20:23], v[32:35]
    v_mfma_f32_16x16x32_bf16 v[32:35], a[8:11], v[24:27], v[32:35]
    v_mfma_f32_16x16x32_bf16 v[32:35], a[12:15], v[28:31], v[32:35]
    v_mfma_f32_16x16x32_bf16 v[36:39], a[16:19], v[16:19], 0
    v_mfma_f32_16x16x32_bf16 v[36:39], a[20:23], v[20:23], v[36:39]
    v_mfma_f32_16x16x32_bf16 v[36:39], a[24:27], v[24:27], v[36:39]
    v_mfma_f32_16x16x32_bf16 v[36:39], a[28:31], v[28:31], v[36:39]
    v_mfma_f32_16x16x32_bf16 v[40:43], a[32:35], v[16:19], 0
    v_mfma_f32_16x16x32_bf16 v[40:43], a[36:39], v[20:23], v[40:43]
    v_mfma_f32_16x16x32_bf16 v[40:43], a[40:43], v[24:27], v[40:43]
    v_mfma_f32_16x16x32_bf16 v[40:43], a[44:47], v[28:31], v[40:43]
    v_mfma_f32_16x16x32_bf16 v[44:47], a[48:51], v[16:19], 0
    v_mfma_f32_16x16x32_bf16 v[44:47], a[52:55], v[20:23], v[44:47]
    v_mfma_f32_16x16x32_bf16 v[44:47], a[56:59], v[24:27], v[44:47]
    v_mfma_f32_16x16x32_bf16 v[44:47], a[60:63], v[28:31], v[44:47]
    v_mfma_f32_16x16x32_bf16 v[48:51], a[64:67], v[16:19], 0
    v_mfma_f32_16x16x32_bf16 v[48:51], a[68:71], v[20:23], v[48:51]
    v_mfma_f32_16x16x32_bf16 v[48:51], a[72:75], v[24:27], v[48:51]
    v_mfma_f32_16x16x32_bf16 v[48:51], a[76:79], v[28:31], v[48:51]
    v_mfma_f32_16x16x32_bf16 v[52:55], a[80:83], v[16:19], 0
    v_mfma_f32_16x16x32_bf16 v[52:55], a[84:87], v[20:23], v[52:55]
    v_mfma_f32_16x16x32_bf16 v[52:55], a[88:91], v[24:27], v[52:55]
    v_mfma_f32_16x16x32_bf16 v[52:55], a[92:95], v[28:31], v[52:55]
    v_mfma_f32_16x16x32_bf16 v[56:59], a[96:99], v[16:19], 0
    v_mfma_f32_16x16x32_bf16 v[56:59], a[100:103], v[20:23], v[56:59]
    v_mfma_f32_16x16x32_bf16 v[56:59], a[104:107], v[24:27], v[56:59]
    v_mfma_f32_16x16x32_bf16 v[56:59], a[108:111], v[28:31], v[56:59]
    v_mfma_f32_16x16x32_bf16 v[60:63], a[112:115], v[16:19], 0
    v_mfma_f32_16x16x32_bf16 v[60:63], a[116:119], v[20:23], v[60:63]
    v_mfma_f32_16x16x32_bf16 v[60:63], a[120:123], v[24:27], v[60:63]
    v_mfma_f32_16x16x32_bf16 v[60:63], a[124:127], v[28:31], v[60:63]
    s_nop 7
    s_nop 3
    v_max3_f32 v7, v32, v33, v34
    v_max3_f32 v7, v7, v35, v36
    v_max3_f32 v7, v7, v37, v38
    v_max3_f32 v7, v7, v39, v40
    v_max3_f32 v7, v7, v41, v42
    v_max3_f32 v7, v7, v43, v44
    v_max3_f32 v7, v7, v45, v46
    v_max3_f32 v7, v7, v47, v48
    v_max3_f32 v7, v7, v49, v50
    v_max3_f32 v7, v7, v51, v52
    v_max3_f32 v7, v7, v53, v54
    v_max3_f32 v7, v7, v55, v56
    v_max3_f32 v7, v7, v57, v58
    v_max3_f32 v7, v7, v59, v60
    v_max3_f32 v7, v7, v61, v62
    v_max_f32 v7, v7, v63
    v_mov_b32 v8, v7
    s_nop 1
    v_permlane16_swap_b32 v7, v8
    s_nop 1
    v_max_f32 v7, v7, v8
    v_mov_b32 v8, v7
    s_nop 1
    v_permlane32_swap_b32 v7, v8
    s_nop 1
    v_max_f32 v7, v7, v8
    v_mul_f32 v7, s33, v7
    v_fma_f32 v32, v32, s33, -v7
    v_fma_f32 v33, v33, s33, -v7
    v_fma_f32 v34, v34, s33, -v7
    v_fma_f32 v35, v35, s33, -v7
    v_fma_f32 v36, v36, s33, -v7
    v_fma_f32 v37, v37, s33, -v7
    v_fma_f32 v38, v38, s33, -v7
    v_fma_f32 v39, v39, s33, -v7
    v_fma_f32 v40, v40, s33, -v7
    v_fma_f32 v41, v41, s33, -v7
    v_fma_f32 v42, v42, s33, -v7
    v_fma_f32 v43, v43, s33, -v7
    v_fma_f32 v44, v44, s33, -v7
    v_fma_f32 v45, v45, s33, -v7
    v_fma_f32 v46, v46, s33, -v7
    v_fma_f32 v47, v47, s33, -v7
    v_fma_f32 v48, v48, s33, -v7
    v_fma_f32 v49, v49, s33, -v7
    v_fma_f32 v50, v50, s33, -v7
    v_fma_f32 v51, v51, s33, -v7
    v_fma_f32 v52, v52, s33, -v7
    v_fma_f32 v53, v53, s33, -v7
    v_fma_f32 v54, v54, s33, -v7
    v_fma_f32 v55, v55, s33, -v7
    v_fma_f32 v56, v56, s33, -v7
    v_fma_f32 v57, v57, s33, -v7
    v_fma_f32 v58, v58, s33, -v7
    v_fma_f32 v59, v59, s33, -v7
    v_fma_f32 v60, v60, s33, -v7
    v_fma_f32 v61, v61, s33, -v7
    v_fma_f32 v62, v62, s33, -v7
    v_fma_f32 v63, v63, s33, -v7
    v_exp_f32 v32, v32
    v_exp_f32 v33, v33
    v_exp_f32 v34, v34
    v_exp_f32 v35, v35
    v_exp_f32 v36, v36
    v_exp_f32 v37, v37
    v_exp_f32 v38, v38
    v_exp_f32 v39, v39
    v_exp_f32 v40, v40
    v_exp_f32 v41, v41
    v_exp_f32 v42, v42
    v_exp_f32 v43, v43
    v_exp_f32 v44, v44
    v_exp_f32 v45, v45
    v_exp_f32 v46, v46
    v_exp_f32 v47, v47
    v_exp_f32 v48, v48
    v_exp_f32 v49, v49
    v_exp_f32 v50, v50
    v_exp_f32 v51, v51
    v_exp_f32 v52, v52
    v_exp_f32 v53, v53
    v_exp_f32 v54, v54
    v_exp_f32 v55, v55
    v_exp_f32 v56, v56
    v_exp_f32 v57, v57
    v_exp_f32 v58, v58
    v_exp_f32 v59, v59
    v_exp_f32 v60, v60
    v_exp_f32 v61, v61
    v_exp_f32 v62, v62
    v_exp_f32 v63, v63
    s_nop 0
    v_add_f32 v9, v32, v33
    v_add_f32 v9, v9, v34
    v_add_f32 v9, v9, v35
    v_add_f32 v9, v9, v36
    v_add_f32 v9, v9, v37
    v_add_f32 v9, v9, v38
    v_add_f32 v9, v9, v39
    v_add_f32 v9, v9, v40
    v_add_f32 v9, v9, v41
    v_add_f32 v9, v9, v42
    v_add_f32 v9, v9, v43
    v_add_f32 v9, v9, v44
    v_add_f32 v9, v9, v45
    v_add_f32 v9, v9, v46
    v_add_f32 v9, v9, v47
    v_add_f32 v9, v9, v48
    v_add_f32 v9, v9, v49
    v_add_f32 v9, v9, v50
    v_add_f32 v9, v9, v51
    v_add_f32 v9, v9, v52
    v_add_f32 v9, v9, v53
    v_add_f32 v9, v9, v54
    v_add_f32 v9, v9, v55
    v_add_f32 v9, v9, v56
    v_add_f32 v9, v9, v57
    v_add_f32 v9, v9, v58
    v_add_f32 v9, v9, v59
    v_add_f32 v9, v9, v60
    v_add_f32 v9, v9, v61
    v_add_f32 v9, v9, v62
    v_add_f32 v9, v9, v63
    v_mov_b32 v8, v9
    s_nop 1
    v_permlane16_swap_b32 v9, v8
    s_nop 1
    v_add_f32 v9, v9, v8
    v_mov_b32 v8, v9
    s_nop 1
    v_permlane32_swap_b32 v9, v8
    s_nop 1
    v_add_f32 v9, v9, v8
    v_cvt_pk_bf16_f32 v96, v32, v33
    v_cvt_pk_bf16_f32 v97, v34, v35
    v_cvt_pk_bf16_f32 v98, v36, v37
    v_cvt_pk_bf16_f32 v99, v38, v39
    v_cvt_pk_bf16_f32 v100, v40, v41
    v_cvt_pk_bf16_f32 v101, v42, v43
    v_cvt_pk_bf16_f32 v102, v44, v45
    v_cvt_pk_bf16_f32 v103, v46, v47
    v_cvt_pk_bf16_f32 v104, v48, v49
    v_cvt_pk_bf16_f32 v105, v50, v51
    v_cvt_pk_bf16_f32 v106, v52, v53
    v_cvt_pk_bf16_f32 v107, v54, v55
    v_cvt_pk_bf16_f32 v108, v56, v57
    v_cvt_pk_bf16_f32 v109, v58, v59
    v_cvt_pk_bf16_f32 v110, v60, v61
    v_cvt_pk_bf16_f32 v111, v62, v63
    s_waitcnt vmcnt(24)
    v_perm_b32 v112, v132, v128, s30
    v_perm_b32 v113, v140, v136, s30
    v_perm_b32 v114, v148, v144, s30
    v_perm_b32 v115, v156, v152, s30
    s_nop 1
    v_mfma_f32_16x16x32_bf16 v[64:67], v[112:115], v[96:99], 0
    v_perm_b32 v116, v132, v128, s31
    v_perm_b32 v117, v140, v136, s31
    v_perm_b32 v118, v148, v144, s31
    v_perm_b32 v119, v156, v152, s31
    s_nop 1
    v_mfma_f32_16x16x32_bf16 v[68:71], v[116:119], v[96:99], 0
    v_perm_b32 v112, v133, v129, s30
    v_perm_b32 v113, v141, v137, s30
    v_perm_b32 v114, v149, v145, s30
    v_perm_b32 v115, v157, v153, s30
    s_nop 1
    v_mfma_f32_16x16x32_bf16 v[72:75], v[112:115], v[96:99], 0
    v_perm_b32 v116, v133, v129, s31
    v_perm_b32 v117, v141, v137, s31
    v_perm_b32 v118, v149, v145, s31
    v_perm_b32 v119, v157, v153, s31
    s_nop 1
    v_mfma_f32_16x16x32_bf16 v[76:79], v[116:119], v[96:99], 0
    v_perm_b32 v112, v134, v130, s30
    v_perm_b32 v113, v142, v138, s30
    v_perm_b32 v114, v150, v146, s30
    v_perm_b32 v115, v158, v154, s30
    s_nop 1
    v_mfma_f32_16x16x32_bf16 v[80:83], v[112:115], v[96:99], 0
    v_perm_b32 v116, v134, v130, s31
    v_perm_b32 v117, v142, v138, s31
    v_perm_b32 v118, v150, v146, s31
    v_perm_b32 v119, v158, v154, s31
    s_nop 1
    v_mfma_f32_16x16x32_bf16 v[84:87], v[116:119], v[96:99], 0
    v_perm_b32 v112, v135, v131, s30
    v_perm_b32 v113, v143, v139, s30
    v_perm_b32 v114, v151, v147, s30
    v_perm_b32 v115, v159, v155, s30
    s_nop 1
    v_mfma_f32_16x16x32_bf16 v[88:91], v[112:115], v[96:99], 0
    v_perm_b32 v116, v135, v131, s31
    v_perm_b32 v117, v143, v139, s31
    v_perm_b32 v118, v151, v147, s31
    v_perm_b32 v119, v159, v155, s31
    s_nop 1
    v_mfma_f32_16x16x32_bf16 v[92:95], v[116:119], v[96:99], 0
    s_waitcnt vmcnt(16)
    v_perm_b32 v112, v164, v160, s30
    v_perm_b32 v113, v172, v168, s30
    v_perm_b32 v114, v180, v176, s30
    v_perm_b32 v115, v188, v184, s30
    s_nop 1
    v_mfma_f32_16x16x32_bf16 v[64:67], v[112:115], v[100:103], v[64:67]
    v_perm_b32 v116, v164, v160, s31
    v_perm_b32 v117, v172, v168, s31
    v_perm_b32 v118, v180, v176, s31
    v_perm_b32 v119, v188, v184, s31
    s_nop 1
    v_mfma_f32_16x16x32_bf16 v[68:71], v[116:119], v[100:103], v[68:71]
    v_perm_b32 v112, v165, v161, s30
    v_perm_b32 v113, v173, v169, s30
    v_perm_b32 v114, v181, v177, s30
    v_perm_b32 v115, v189, v185, s30
    s_nop 1
    v_mfma_f32_16x16x32_bf16 v[72:75], v[112:115], v[100:103], v[72:75]
    v_perm_b32 v116, v165, v161, s31
    v_perm_b32 v117, v173, v169, s31
    v_perm_b32 v118, v181, v177, s31
    v_perm_b32 v119, v189, v185, s31
    s_nop 1
    v_mfma_f32_16x16x32_bf16 v[76:79], v[116:119], v[100:103], v[76:79]
    v_perm_b32 v112, v166, v162, s30
    v_perm_b32 v113, v174, v170, s30
    v_perm_b32 v114, v182, v178, s30
    v_perm_b32 v115, v190, v186, s30
    s_nop 1
    v_mfma_f32_16x16x32_bf16 v[80:83], v[112:115], v[100:103], v[80:83]
    v_perm_b32 v116, v166, v162, s31
    v_perm_b32 v117, v174, v170, s31
    v_perm_b32 v118, v182, v178, s31
    v_perm_b32 v119, v190, v186, s31
    s_nop 1
    v_mfma_f32_16x16x32_bf16 v[84:87], v[116:119], v[100:103], v[84:87]
    v_perm_b32 v112, v167, v163, s30
    v_perm_b32 v113, v175, v171, s30
    v_perm_b32 v114, v183, v179, s30
    v_perm_b32 v115, v191, v187, s30
    s_nop 1
    v_mfma_f32_16x16x32_bf16 v[88:91], v[112:115], v[100:103], v[88:91]
    v_perm_b32 v116, v167, v163, s31
    v_perm_b32 v117, v175, v171, s31
    v_perm_b32 v118, v183, v179, s31
    v_perm_b32 v119, v191, v187, s31
    s_nop 1
    v_mfma_f32_16x16x32_bf16 v[92:95], v[116:119], v[100:103], v[92:95]
    s_waitcnt vmcnt(8)
    v_perm_b32 v112, v196, v192, s30
    v_perm_b32 v113, v204, v200, s30
    v_perm_b32 v114, v212, v208, s30
    v_perm_b32 v115, v220, v216, s30
    s_nop 1
    v_mfma_f32_16x16x32_bf16 v[64:67], v[112:115], v[104:107], v[64:67]
    v_perm_b32 v116, v196, v192, s31
    v_perm_b32 v117, v204, v200, s31
    v_perm_b32 v118, v212, v208, s31
    v_perm_b32 v119, v220, v216, s31
    s_nop 1
    v_mfma_f32_16x16x32_bf16 v[68:71], v[116:119], v[104:107], v[68:71]
    v_perm_b32 v112, v197, v193, s30
    v_perm_b32 v113, v205, v201, s30
    v_perm_b32 v114, v213, v209, s30
    v_perm_b32 v115, v221, v217, s30
    s_nop 1
    v_mfma_f32_16x16x32_bf16 v[72:75], v[112:115], v[104:107], v[72:75]
    v_perm_b32 v116, v197, v193, s31
    v_perm_b32 v117, v205, v201, s31
    v_perm_b32 v118, v213, v209, s31
    v_perm_b32 v119, v221, v217, s31
    s_nop 1
    v_mfma_f32_16x16x32_bf16 v[76:79], v[116:119], v[104:107], v[76:79]
    v_perm_b32 v112, v198, v194, s30
    v_perm_b32 v113, v206, v202, s30
    v_perm_b32 v114, v214, v210, s30
    v_perm_b32 v115, v222, v218, s30
    s_nop 1
    v_mfma_f32_16x16x32_bf16 v[80:83], v[112:115], v[104:107], v[80:83]
    v_perm_b32 v116, v198, v194, s31
    v_perm_b32 v117, v206, v202, s31
    v_perm_b32 v118, v214, v210, s31
    v_perm_b32 v119, v222, v218, s31
    s_nop 1
    v_mfma_f32_16x16x32_bf16 v[84:87], v[116:119], v[104:107], v[84:87]
    v_perm_b32 v112, v199, v195, s30
    v_perm_b32 v113, v207, v203, s30
    v_perm_b32 v114, v215, v211, s30
    v_perm_b32 v115, v223, v219, s30
    s_nop 1
    v_mfma_f32_16x16x32_bf16 v[88:91], v[112:115], v[104:107], v[88:91]
    v_perm_b32 v116, v199, v195, s31
    v_perm_b32 v117, v207, v203, s31
    v_perm_b32 v118, v215, v211, s31
    v_perm_b32 v119, v223, v219, s31
    s_nop 1
    v_mfma_f32_16x16x32_bf16 v[92:95], v[116:119], v[104:107], v[92:95]
    s_waitcnt vmcnt(0)
    v_perm_b32 v112, v228, v224, s30
    v_perm_b32 v113, v236, v232, s30
    v_perm_b32 v114, v244, v240, s30
    v_perm_b32 v115, v252, v248, s30
    s_nop 1
    v_mfma_f32_16x16x32_bf16 v[64:67], v[112:115], v[108:111], v[64:67]
    v_perm_b32 v116, v228, v224, s31
    v_perm_b32 v117, v236, v232, s31
    v_perm_b32 v118, v244, v240, s31
    v_perm_b32 v119, v252, v248, s31
    s_nop 1
    v_mfma_f32_16x16x32_bf16 v[68:71], v[116:119], v[108:111], v[68:71]
    v_perm_b32 v112, v229, v225, s30
    v_perm_b32 v113, v237, v233, s30
    v_perm_b32 v114, v245, v241, s30
    v_perm_b32 v115, v253, v249, s30
    s_nop 1
    v_mfma_f32_16x16x32_bf16 v[72:75], v[112:115], v[108:111], v[72:75]
    v_perm_b32 v116, v229, v225, s31
    v_perm_b32 v117, v237, v233, s31
    v_perm_b32 v118, v245, v241, s31
    v_perm_b32 v119, v253, v249, s31
    s_nop 1
    v_mfma_f32_16x16x32_bf16 v[76:79], v[116:119], v[108:111], v[76:79]
    v_perm_b32 v112, v230, v226, s30
    v_perm_b32 v113, v238, v234, s30
    v_perm_b32 v114, v246, v242, s30
    v_perm_b32 v115, v254, v250, s30
    s_nop 1
    v_mfma_f32_16x16x32_bf16 v[80:83], v[112:115], v[108:111], v[80:83]
    v_perm_b32 v116, v230, v226, s31
    v_perm_b32 v117, v238, v234, s31
    v_perm_b32 v118, v246, v242, s31
    v_perm_b32 v119, v254, v250, s31
    s_nop 1
    v_mfma_f32_16x16x32_bf16 v[84:87], v[116:119], v[108:111], v[84:87]
    v_perm_b32 v112, v231, v227, s30
    v_perm_b32 v113, v239, v235, s30
    v_perm_b32 v114, v247, v243, s30
    v_perm_b32 v115, v255, v251, s30
    s_nop 1
    v_mfma_f32_16x16x32_bf16 v[88:91], v[112:115], v[108:111], v[88:91]
    v_perm_b32 v116, v231, v227, s31
    v_perm_b32 v117, v239, v235, s31
    v_perm_b32 v118, v247, v243, s31
    v_perm_b32 v119, v255, v251, s31
    s_nop 1
    v_mfma_f32_16x16x32_bf16 v[92:95], v[116:119], v[108:111], v[92:95]
    s_nop 7
    s_nop 3
    v_and_b32 v10, 3, v3
    s_lshl_b32 s38, s29, 4
    v_lshlrev_b32 v11, 2, v10
    v_add_u32 v12, s38, v11
    v_cmp_gt_u32 vcc, 4, v1
    s_and_saveexec_b64 s[40:41], vcc
    ds_write_b32 v12, v7 offset:8192
    s_mov_b64 exec, s[40:41]
    s_waitcnt lgkmcnt(0)
    s_barrier
    ds_read_b32 v13, v11 offset:8192
    ds_read_b32 v14, v11 offset:8208
    ds_read_b32 v15, v11 offset:8224
    ds_read_b32 v8, v11 offset:8240
    s_waitcnt lgkmcnt(0)
    v_max3_f32 v13, v13, v14, v15
    v_max_f32 v13, v13, v8
    v_sub_f32 v14, v7, v13
    v_exp_f32 v14, v14
    s_nop 0
    v_mul_f32 v9, v9, v14
    v_mul_f32 v64, v64, v14
    v_mul_f32 v65, v65, v14
    v_mul_f32 v66, v66, v14
    v_mul_f32 v67, v67, v14
    v_mul_f32 v68, v68, v14
    v_mul_f32 v69, v69, v14
    v_mul_f32 v70, v70, v14
    v_mul_f32 v71, v71, v14
    v_mul_f32 v72, v72, v14
    v_mul_f32 v73, v73, v14
    v_mul_f32 v74, v74, v14
    v_mul_f32 v75, v75, v14
    v_mul_f32 v76, v76, v14
    v_mul_f32 v77, v77, v14
    v_mul_f32 v78, v78, v14
    v_mul_f32 v79, v79, v14
    v_mul_f32 v80, v80, v14
    v_mul_f32 v81, v81, v14
    v_mul_f32 v82, v82, v14
    v_mul_f32 v83, v83, v14
    v_mul_f32 v84, v84, v14
    v_mul_f32 v85, v85, v14
    v_mul_f32 v86, v86, v14
    v_mul_f32 v87, v87, v14
    v_mul_f32 v88, v88, v14
    v_mul_f32 v89, v89, v14
    v_mul_f32 v90, v90, v14
    v_mul_f32 v91, v91, v14
    v_mul_f32 v92, v92, v14
    v_mul_f32 v93, v93, v14
    v_mul_f32 v94, v94, v14
    v_mul_f32 v95, v95, v14
    v_lshlrev_b32 v15, 9, v3
    v_lshl_add_u32 v15, v2, 7, v15
    s_lshl_b32 s38, s29, 11
    v_add_u32 v15, s38, v15
    v_cmp_gt_u32 vcc, 4, v3
    s_and_saveexec_b64 s[40:41], vcc
    ds_write_b128 v15, v[64:67] offset:0
    ds_write_b128 v15, v[68:71] offset:16
    ds_write_b128 v15, v[72:75] offset:32
    ds_write_b128 v15, v[76:79] offset:48
    ds_write_b128 v15, v[80:83] offset:64
    ds_write_b128 v15, v[84:87] offset:80
    ds_write_b128 v15, v[88:91] offset:96
    ds_write_b128 v15, v[92:95] offset:112
    s_mov_b64 exec, s[40:41]
    v_cmp_gt_u32 vcc, 4, v1
    s_and_saveexec_b64 s[40:41], vcc
    ds_write_b32 v12, v9 offset:8256
    s_mov_b64 exec, s[40:41]
    s_waitcnt lgkmcnt(0)
    s_barrier
    v_lshlrev_b32 v16, 2, v0
    ds_read_b32 v20, v16
    ds_read_b32 v21, v16 offset:2048
    ds_read_b32 v22, v16 offset:4096
    ds_read_b32 v23, v16 offset:6144
    ds_read_b32 v24, v16 offset:1024
    ds_read_b32 v25, v16 offset:3072
    ds_read_b32 v26, v16 offset:5120
    ds_read_b32 v27, v16 offset:7168
    s_waitcnt lgkmcnt(0)
    v_add_f32 v20, v20, v21
    v_add_f32 v22, v22, v23
    v_add_f32 v20, v20, v22
    v_add_f32 v24, v24, v25
    v_add_f32 v26, v26, v27
    v_add_f32 v24, v24, v26
    v_lshrrev_b32 v17, 7, v0
    v_bfe_u32 v18, v0, 5, 2
    v_bfe_u32 v19, v0, 2, 3
    v_and_b32 v21, 3, v0
    v_lshlrev_b32 v18, 5, v18
    v_lshl_add_u32 v18, v21, 3, v18
    v_add_u32 v18, v18, v19
    v_lshlrev_b32 v17, 11, v17
    v_lshl_add_u32 v18, v18, 2, v17
    s_lshl_b32 s38, s34, 13
    s_lshl_b32 s39, s35, 9
    s_add_u32 s38, s38, s39
    s_add_u32 s38, s38, 0x40000
    buffer_store_dword v20, v18, s[24:27], s38 offen
    s_add_u32 s38, s38, 4096
    buffer_store_dword v24, v18, s[24:27], s38 offen
    v_cmp_gt_u32 vcc, 4, v0
    s_and_saveexec_b64 s[40:41], vcc
    ds_read_b32 v20, v16 offset:8256
    ds_read_b32 v21, v16 offset:8272
    ds_read_b32 v22, v16 offset:8288
    ds_read_b32 v23, v16 offset:8304
    s_waitcnt lgkmcnt(0)
    v_add_f32 v20, v20, v21
    v_add_f32 v22, v22, v23
    v_add_f32 v29, v20, v22
    v_mov_b32 v28, v13
    v_lshlrev_b32 v17, 5, v0
    s_lshl_b32 s38, s34, 7
    s_lshl_b32 s39, s35, 3
    s_add_u32 s38, s38, s39
    s_add_u32 s38, s38, 0x80000
    buffer_store_dwordx2 v[28:29], v17, s[24:27], s38 offen
    s_endpgm
Lk2_b:
    s_load_dwordx2 s[4:5], s[0:1], 48
    s_waitcnt lgkmcnt(0)
    s_mov_b32 s12, s4
    s_mov_b32 s13, s5
    s_mov_b32 s14, 0x2000000
    s_mov_b32 s15, 0x00020000
    s_mov_b32 s24, s10
    s_mov_b32 s25, s11
    s_mov_b32 s26, 0x10000000
    s_mov_b32 s27, 0x00020000
    s_lshr_b32 s34, s3, 5
    s_and_b32 s35, s3, 31
    s_and_b32 s42, s29, 1
    s_lshr_b32 s43, s29, 1
    v_lshlrev_b32 v5, 10, v3
    v_lshl_add_u32 v5, v2, 4, v5
    s_lshl_b32 s36, s34, 15
    s_lshl_b32 s37, s42, 14
    s_add_u32 s36, s36, s37
    s_add_u32 s36, s36, 0x10000
    buffer_load_dwordx4 a[0:3], v5, s[24:27], s36 offen offset:0
    buffer_load_dwordx4 a[4:7], v5, s[24:27], s36 offen offset:64
    buffer_load_dwordx4 a[8:11], v5, s[24:27], s36 offen offset:128
    buffer_load_dwordx4 a[12:15], v5, s[24:27], s36 offen offset:192
    buffer_load_dwordx4 a[16:19], v5, s[24:27], s36 offen offset:256
    buffer_load_dwordx4 a[20:23], v5, s[24:27], s36 offen offset:320
    buffer_load_dwordx4 a[24:27], v5, s[24:27], s36 offen offset:384
    buffer_load_dwordx4 a[28:31], v5, s[24:27], s36 offen offset:448
    buffer_load_dwordx4 a[32:35], v5, s[24:27], s36 offen offset:512
    buffer_load_dwordx4 a[36:39], v5, s[24:27], s36 offen offset:576
    buffer_load_dwordx4 a[40:43], v5, s[24:27], s36 offen offset:640
    buffer_load_dwordx4 a[44:47], v5, s[24:27], s36 offen offset:704
    buffer_load_dwordx4 a[48:51], v5, s[24:27], s36 offen offset:768
    buffer_load_dwordx4 a[52:55], v5, s[24:27], s36 offen offset:832
    buffer_load_dwordx4 a[56:59], v5, s[24:27], s36 offen offset:896
    buffer_load_dwordx4 a[60:63], v5, s[24:27], s36 offen offset:960
    v_lshlrev_b32 v6, 4, v1
    s_lshl_b32 s44, s3, 18
    s_lshl_b32 s37, s29, 14
    s_add_u32 s44, s44, s37
    s_mul_i32 s45, s29, 16640
    s_add_u32 m0, s45, 0
    s_add_u32 s46, s44, 0
    buffer_load_dwordx4 v6, s[12:15], s46 offen nt lds
    s_add_u32 s46, s46, 1024
    s_add_u32 m0, m0, 1040
    s_nop 0
    buffer_load_dwordx4 v6, s[12:15], s46 offen nt lds
    s_add_u32 s46, s46, 1024
    s_add_u32 m0, m0, 1040
    s_nop 0
    buffer_load_dwordx4 v6, s[12:15], s46 offen nt lds
    s_add_u32 s46, s46, 1024
    s_add_u32 m0, m0, 1040
    s_nop 0
    buffer_load_dwordx4 v6, s[12:15], s46 offen nt lds
    s_add_u32 s46, s46, 1024
    s_add_u32 m0, m0, 1040
    s_nop 0
    buffer_load_dwordx4 v6, s[12:15], s46 offen nt lds
    s_add_u32 s46, s46, 1024
    s_add_u32 m0, m0, 1040
    s_nop 0
    buffer_load_dwordx4 v6, s[12:15], s46 offen nt lds
    s_add_u32 s46, s46, 1024
    s_add_u32 m0, m0, 1040
    s_nop 0
    buffer_load_dwordx4 v6, s[12:15], s46 offen nt lds
    s_add_u32 s46, s46, 1024
    s_add_u32 m0, m0, 1040
    s_nop 0
    buffer_load_dwordx4 v6, s[12:15], s46 offen nt lds
    s_add_u32 s46, s46, 1024
    s_add_u32 m0, m0, 1040
    s_nop 0
    buffer_load_dwordx4 v6, s[12:15], s46 offen nt lds
    s_add_u32 s46, s46, 1024
    s_add_u32 m0, m0, 1040
    s_nop 0
    buffer_load_dwordx4 v6, s[12:15], s46 offen nt lds
    s_add_u32 s46, s46, 1024
    s_add_u32 m0, m0, 1040
    s_nop 0
    buffer_load_dwordx4 v6, s[12:15], s46 offen nt lds
    s_add_u32 s46, s46, 1024
    s_add_u32 m0, m0, 1040
    s_nop 0
    buffer_load_dwordx4 v6, s[12:15], s46 offen nt lds
    s_add_u32 s46, s46, 1024
    s_add_u32 m0, m0, 1040
    s_nop 0
    buffer_load_dwordx4 v6, s[12:15], s46 offen nt lds
    s_add_u32 s46, s46, 1024
    s_add_u32 m0, m0, 1040
    s_nop 0
    buffer_load_dwordx4 v6, s[12:15], s46 offen nt lds
    s_add_u32 s46, s46, 1024
    s_add_u32 m0, m0, 1040
    s_nop 0
    buffer_load_dwordx4 v6, s[12:15], s46 offen nt lds
    s_add_u32 s46, s46, 1024
    s_add_u32 m0, m0, 1040
    s_nop 0
    buffer_load_dwordx4 v6, s[12:15], s46 offen nt lds
    s_add_u32 m0, s45, 66560
    s_add_u32 s46, s44, 65536
    buffer_load_dwordx4 v6, s[12:15], s46 offen nt lds
    s_add_u32 s46, s46, 1024
    s_add_u32 m0, m0, 1040
    s_nop 0
    buffer_load_dwordx4 v6, s[12:15], s46 offen nt lds
    s_add_u32 s46, s46, 1024
    s_add_u32 m0, m0, 1040
    s_nop 0
    buffer_load_dwordx4 v6, s[12:15], s46 offen nt lds
    s_add_u32 s46, s46, 1024
    s_add_u32 m0, m0, 1040
    s_nop 0
    buffer_load_dwordx4 v6, s[12:15], s46 offen nt lds
    s_add_u32 s46, s46, 1024
    s_add_u32 m0, m0, 1040
    s_nop 0
    buffer_load_dwordx4 v6, s[12:15], s46 offen nt lds
    s_add_u32 s46, s46, 1024
    s_add_u32 m0, m0, 1040
    s_nop 0
    buffer_load_dwordx4 v6, s[12:15], s46 offen nt lds
    s_add_u32 s46, s46, 1024
    s_add_u32 m0, m0, 1040
    s_nop 0
    buffer_load_dwordx4 v6, s[12:15], s46 offen nt lds
    s_add_u32 s46, s46, 1024
    s_add_u32 m0, m0, 1040
    s_nop 0
    buffer_load_dwordx4 v6, s[12:15], s46 offen nt lds
    s_add_u32 s46, s46, 1024
    s_add_u32 m0, m0, 1040
    s_nop 0
    buffer_load_dwordx4 v6, s[12:15], s46 offen nt lds
    s_add_u32 s46, s46, 1024
    s_add_u32 m0, m0, 1040
    s_nop 0
    buffer_load_dwordx4 v6, s[12:15], s46 offen nt lds
    s_add_u32 s46, s46, 1024
    s_add_u32 m0, m0, 1040
    s_nop 0
    buffer_load_dwordx4 v6, s[12:15], s46 offen nt lds
    s_add_u32 s46, s46, 1024
    s_add_u32 m0, m0, 1040
    s_nop 0
    buffer_load_dwordx4 v6, s[12:15], s46 offen nt lds
    s_add_u32 s46, s46, 1024
    s_add_u32 m0, m0, 1040
    s_nop 0
    buffer_load_dwordx4 v6, s[12:15], s46 offen nt lds
    s_add_u32 s46, s46, 1024
    s_add_u32 m0, m0, 1040
    s_nop 0
    buffer_load_dwordx4 v6, s[12:15], s46 offen nt lds
    s_add_u32 s46, s46, 1024
    s_add_u32 m0, m0, 1040
    s_nop 0
    buffer_load_dwordx4 v6, s[12:15], s46 offen nt lds
    s_add_u32 s46, s46, 1024
    s_add_u32 m0, m0, 1040
    s_nop 0
    buffer_load_dwordx4 v6, s[12:15], s46 offen nt lds
    v_mov_b32 v10, 0xf149f2ca
    v_mov_b32 v11, 0
    v_mov_b32 v128, 0
    v_mov_b32 v129, 0
    v_mov_b32 v130, 0
    v_mov_b32 v131, 0
    v_mov_b32 v132, 0
    v_mov_b32 v133, 0
    v_mov_b32 v134, 0
    v_mov_b32 v135, 0
    v_mov_b32 v136, 0
    v_mov_b32 v137, 0
    v_mov_b32 v138, 0
    v_mov_b32 v139, 0
    v_mov_b32 v140, 0
    v_mov_b32 v141, 0
    v_mov_b32 v142, 0
    v_mov_b32 v143, 0
    v_mov_b32 v144, 0
    v_mov_b32 v145, 0
    v_mov_b32 v146, 0
    v_mov_b32 v147, 0
    v_mov_b32 v148, 0
    v_mov_b32 v149, 0
    v_mov_b32 v150, 0
    v_mov_b32 v151, 0
    v_mov_b32 v152, 0
    v_mov_b32 v153, 0
    v_mov_b32 v154, 0
    v_mov_b32 v155, 0
    v_mov_b32 v156, 0
    v_mov_b32 v157, 0
    v_mov_b32 v158, 0
    v_mov_b32 v159, 0
    v_mov_b32 v160, 0
    v_mov_b32 v161, 0
    v_mov_b32 v162, 0
    v_mov_b32 v163, 0
    v_mov_b32 v164, 0
    v_mov_b32 v165, 0
    v_mov_b32 v166, 0
    v_mov_b32 v167, 0
    v_mov_b32 v168, 0
    v_mov_b32 v169, 0
    v_mov_b32 v170, 0
    v_mov_b32 v171, 0
    v_mov_b32 v172, 0
    v_mov_b32 v173, 0
    v_mov_b32 v174, 0
    v_mov_b32 v175, 0
    v_mov_b32 v176, 0
    v_mov_b32 v177, 0
    v_mov_b32 v178, 0
    v_mov_b32 v179, 0
    v_mov_b32 v180, 0
    v_mov_b32 v181, 0
    v_mov_b32 v182, 0
    v_mov_b32 v183, 0
    v_mov_b32 v184, 0
    v_mov_b32 v185, 0
    v_mov_b32 v186, 0
    v_mov_b32 v187, 0
    v_mov_b32 v188, 0
    v_mov_b32 v189, 0
    v_mov_b32 v190, 0
    v_mov_b32 v191, 0
    v_mov_b32 v192, 0
    v_mov_b32 v193, 0
    v_mov_b32 v194, 0
    v_mov_b32 v195, 0
    v_mov_b32 v196, 0
    v_mov_b32 v197, 0
    v_mov_b32 v198, 0
    v_mov_b32 v199, 0
    v_mov_b32 v200, 0
    v_mov_b32 v201, 0
    v_mov_b32 v202, 0
    v_mov_b32 v203, 0
    v_mov_b32 v204, 0
    v_mov_b32 v205, 0
    v_mov_b32 v206, 0
    v_mov_b32 v207, 0
    v_mov_b32 v208, 0
    v_mov_b32 v209, 0
    v_mov_b32 v210, 0
    v_mov_b32 v211, 0
    v_mov_b32 v212, 0
    v_mov_b32 v213, 0
    v_mov_b32 v214, 0
    v_mov_b32 v215, 0
    v_mov_b32 v216, 0
    v_mov_b32 v217, 0
    v_mov_b32 v218, 0
    v_mov_b32 v219, 0
    v_mov_b32 v220, 0
    v_mov_b32 v221, 0
    v_mov_b32 v222, 0
    v_mov_b32 v223, 0
    v_mov_b32 v224, 0
    v_mov_b32 v225, 0
    v_mov_b32 v226, 0
    v_mov_b32 v227, 0
    v_mov_b32 v228, 0
    v_mov_b32 v229, 0
    v_mov_b32 v230, 0
    v_mov_b32 v231, 0
    v_mov_b32 v232, 0
    v_mov_b32 v233, 0
    v_mov_b32 v234, 0
    v_mov_b32 v235, 0
    v_mov_b32 v236, 0
    v_mov_b32 v237, 0
    v_mov_b32 v238, 0
    v_mov_b32 v239, 0
    v_mov_b32 v240, 0
    v_mov_b32 v241, 0
    v_mov_b32 v242, 0
    v_mov_b32 v243, 0
    v_mov_b32 v244, 0
    v_mov_b32 v245, 0
    v_mov_b32 v246, 0
    v_mov_b32 v247, 0
    v_mov_b32 v248, 0
    v_mov_b32 v249, 0
    v_mov_b32 v250, 0
    v_mov_b32 v251, 0
    v_mov_b32 v252, 0
    v_mov_b32 v253, 0
    v_mov_b32 v254, 0
    v_mov_b32 v255, 0
    s_mul_i32 s47, s43, 33280
    v_mul_u32_u24 v12, 1040, v3
    v_lshl_add_u32 v12, v2, 4, v12
    v_add_u32 v12, s47, v12
    v_add_u32 v13, 66560, v12
    v_lshrrev_b32 v14, 2, v3
    v_lshl_add_u32 v14, v2, 2, v14
    v_mul_u32_u24 v14, 1040, v14
    v_and_b32 v15, 3, v3
    v_lshl_add_u32 v14, v15, 3, v14
    v_add_u32 v14, s47, v14
    v_add_u32 v15, 66560, v14
    s_waitcnt vmcnt(16)
    s_barrier
    ds_read_b128 v[40:43], v12 offset:0
    ds_read_b128 v[44:47], v12 offset:16640
    ds_read_b128 v[48:51], v12 offset:64
    ds_read_b128 v[52:55], v12 offset:16704
    ds_read_b128 v[56:59], v12 offset:128
    ds_read_b128 v[60:63], v12 offset:16768
    ds_read_b128 v[64:67], v12 offset:192
    ds_read_b128 v[68:71], v12 offset:16832
    s_waitcnt lgkmcnt(7)
    v_mfma_f32_16x16x32_bf16 v[32:35], v[40:43], a[0:3], 0
    ds_read_b128 v[40:43], v12 offset:256
    s_waitcnt lgkmcnt(7)
    v_mfma_f32_16x16x32_bf16 v[36:39], v[44:47], a[0:3], 0
    ds_read_b128 v[44:47], v12 offset:16896
    s_waitcnt lgkmcnt(7)
    v_mfma_f32_16x16x32_bf16 v[32:35], v[48:51], a[4:7], v[32:35]
    ds_read_b128 v[48:51], v12 offset:320
    s_waitcnt lgkmcnt(7)
    v_mfma_f32_16x16x32_bf16 v[36:39], v[52:55], a[4:7], v[36:39]
    ds_read_b128 v[52:55], v12 offset:16960
    s_waitcnt lgkmcnt(7)
    v_mfma_f32_16x16x32_bf16 v[32:35], v[56:59], a[8:11], v[32:35]
    ds_read_b128 v[56:59], v12 offset:384
    s_waitcnt lgkmcnt(7)
    v_mfma_f32_16x16x32_bf16 v[36:39], v[60:63], a[8:11], v[36:39]
    ds_read_b128 v[60:63], v12 offset:17024
    s_waitcnt lgkmcnt(7)
    v_mfma_f32_16x16x32_bf16 v[32:35], v[64:67], a[12:15], v[32:35]
    ds_read_b128 v[64:67], v12 offset:448
    s_waitcnt lgkmcnt(7)
    v_mfma_f32_16x16x32_bf16 v[36:39], v[68:71], a[12:15], v[36:39]
    ds_read_b128 v[68:71], v12 offset:17088
    s_waitcnt lgkmcnt(7)
    v_mfma_f32_16x16x32_bf16 v[32:35], v[40:43], a[16:19], v[32:35]
    ds_read_b128 v[40:43], v12 offset:512
    s_waitcnt lgkmcnt(7)
    v_mfma_f32_16x16x32_bf16 v[36:39], v[44:47], a[16:19], v[36:39]
    ds_read_b128 v[44:47], v12 offset:17152
    s_waitcnt lgkmcnt(7)
    v_mfma_f32_16x16x32_bf16 v[32:35], v[48:51], a[20:23], v[32:35]
    ds_read_b128 v[48:51], v12 offset:576
    s_waitcnt lgkmcnt(7)
    v_mfma_f32_16x16x32_bf16 v[36:39], v[52:55], a[20:23], v[36:39]
    ds_read_b128 v[52:55], v12 offset:17216
    s_waitcnt lgkmcnt(7)
    v_mfma_f32_16x16x32_bf16 v[32:35], v[56:59], a[24:27], v[32:35]
    ds_read_b128 v[56:59], v12 offset:640
    s_waitcnt lgkmcnt(7)
    v_mfma_f32_16x16x32_bf16 v[36:39], v[60:63], a[24:27], v[36:39]
    ds_read_b128 v[60:63], v12 offset:17280
    s_waitcnt lgkmcnt(7)
    v_mfma_f32_16x16x32_bf16 v[32:35], v[64:67], a[28:31], v[32:35]
    ds_read_b128 v[64:67], v12 offset:704
    s_waitcnt lgkmcnt(7)
    v_mfma_f32_16x16x32_bf16 v[36:39], v[68:71], a[28:31], v[36:39]
    ds_read_b128 v[68:71], v12 offset:17344
    s_waitcnt lgkmcnt(7)
    v_mfma_f32_16x16x32_bf16 v[32:35], v[40:43], a[32:35], v[32:35]
    ds_read_b128 v[40:43], v12 offset:768
    s_waitcnt lgkmcnt(7)
    v_mfma_f32_16x16x32_bf16 v[36:39], v[44:47], a[32:35], v[36:39]
    ds_read_b128 v[44:47], v12 offset:17408
    s_waitcnt lgkmcnt(7)
    v_mfma_f32_16x16x32_bf16 v[32:35], v[48:51], a[36:39], v[32:35]
    ds_read_b128 v[48:51], v12 offset:832
    s_waitcnt lgkmcnt(7)
    v_mfma_f32_16x16x32_bf16 v[36:39], v[52:55], a[36:39], v[36:39]
    ds_read_b128 v[52:55], v12 offset:17472
    s_waitcnt lgkmcnt(7)
    v_mfma_f32_16x16x32_bf16 v[32:35], v[56:59], a[40:43], v[32:35]
    ds_read_b128 v[56:59], v12 offset:896
    s_waitcnt lgkmcnt(7)
    v_mfma_f32_16x16x32_bf16 v[36:39], v[60:63], a[40:43], v[36:39]
    ds_read_b128 v[60:63], v12 offset:17536
    s_waitcnt lgkmcnt(7)
    v_mfma_f32_16x16x32_bf16 v[32:35], v[64:67], a[44:47], v[32:35]
    ds_read_b128 v[64:67], v12 offset:960
    s_waitcnt lgkmcnt(7)
    v_mfma_f32_16x16x32_bf16 v[36:39], v[68:71], a[44:47], v[36:39]
    ds_read_b128 v[68:71], v12 offset:17600
    s_waitcnt lgkmcnt(7)
    v_mfma_f32_16x16x32_bf16 v[32:35], v[40:43], a[48:51], v[32:35]
    s_waitcnt lgkmcnt(6)
    v_mfma_f32_16x16x32_bf16 v[36:39], v[44:47], a[48:51], v[36:39]
    s_waitcnt lgkmcnt(5)
    v_mfma_f32_16x16x32_bf16 v[32:35], v[48:51], a[52:55], v[32:35]
    s_waitcnt lgkmcnt(4)
    v_mfma_f32_16x16x32_bf16 v[36:39], v[52:55], a[52:55], v[36:39]
    s_waitcnt lgkmcnt(3)
    v_mfma_f32_16x16x32_bf16 v[32:35], v[56:59], a[56:59], v[32:35]
    s_waitcnt lgkmcnt(2)
    v_mfma_f32_16x16x32_bf16 v[36:39], v[60:63], a[56:59], v[36:39]
    s_waitcnt lgkmcnt(1)
    v_mfma_f32_16x16x32_bf16 v[32:35], v[64:67], a[60:63], v[32:35]
    s_waitcnt lgkmcnt(0)
    v_mfma_f32_16x16x32_bf16 v[36:39], v[68:71], a[60:63], v[36:39]
    ds_read_b64_tr_b16 v[72:73], v14 offset:0
    ds_read_b64_tr_b16 v[74:75], v14 offset:16640
    ds_read_b64_tr_b16 v[76:77], v14 offset:32
    ds_read_b64_tr_b16 v[78:79], v14 offset:16672
    ds_read_b64_tr_b16 v[80:81], v14 offset:64
    ds_read_b64_tr_b16 v[82:83], v14 offset:16704
    ds_read_b64_tr_b16 v[84:85], v14 offset:96
    ds_read_b64_tr_b16 v[86:87], v14 offset:16736
    ds_read_b64_tr_b16 v[88:89], v14 offset:128
    ds_read_b64_tr_b16 v[90:91], v14 offset:16768
    ds_read_b64_tr_b16 v[92:93], v14 offset:160
    ds_read_b64_tr_b16 v[94:95], v14 offset:16800
    s_nop 3
    v_max3_f32 v16, v32, v33, v34
    v_max3_f32 v16, v16, v35, v36
    v_max3_f32 v16, v16, v37, v38
    v_max_f32 v16, v16, v39
    v_mov_b32 v17, v16
    s_nop 1
    v_permlane16_swap_b32 v16, v17
    s_nop 1
    v_max_f32 v16, v16, v17
    v_mov_b32 v17, v16
    s_nop 1
    v_permlane32_swap_b32 v16, v17
    s_nop 1
    v_max_f32 v16, v16, v17
    v_max_f32 v16, v16, v10
    v_sub_f32 v17, v10, v16
    v_mul_f32 v17, s33, v17
    v_exp_f32 v17, v17
    v_mov_b32 v10, v16
    v_mul_f32 v16, s33, v16
    v_fma_f32 v32, v32, s33, -v16
    v_fma_f32 v33, v33, s33, -v16
    v_fma_f32 v34, v34, s33, -v16
    v_fma_f32 v35, v35, s33, -v16
    v_fma_f32 v36, v36, s33, -v16
    v_fma_f32 v37, v37, s33, -v16
    v_fma_f32 v38, v38, s33, -v16
    v_fma_f32 v39, v39, s33, -v16
    v_exp_f32 v32, v32
    v_exp_f32 v33, v33
    v_exp_f32 v34, v34
    v_exp_f32 v35, v35
    v_exp_f32 v36, v36
    v_exp_f32 v37, v37
    v_exp_f32 v38, v38
    v_exp_f32 v39, v39
    v_mul_f32 v11, v11, v17
    v_add_f32 v11, v11, v32
    v_add_f32 v11, v11, v33
    v_add_f32 v11, v11, v34
    v_add_f32 v11, v11, v35
    v_add_f32 v11, v11, v36
    v_add_f32 v11, v11, v37
    v_add_f32 v11, v11, v38
    v_add_f32 v11, v11, v39
    v_cvt_pk_bf16_f32 v104, v32, v33
    v_cvt_pk_bf16_f32 v105, v34, v35
    v_cvt_pk_bf16_f32 v106, v36, v37
    v_cvt_pk_bf16_f32 v107, v38, v39
    v_mul_f32 v128, v128, v17
    v_mul_f32 v129, v129, v17
    v_mul_f32 v130, v130, v17
    v_mul_f32 v131, v131, v17
    v_mul_f32 v132, v132, v17
    v_mul_f32 v133, v133, v17
    v_mul_f32 v134, v134, v17
    v_mul_f32 v135, v135, v17
    v_mul_f32 v136, v136, v17
    v_mul_f32 v137, v137, v17
    v_mul_f32 v138, v138, v17
    v_mul_f32 v139, v139, v17
    v_mul_f32 v140, v140, v17
    v_mul_f32 v141, v141, v17
    v_mul_f32 v142, v142, v17
    v_mul_f32 v143, v143, v17
    v_mul_f32 v144, v144, v17
    v_mul_f32 v145, v145, v17
    v_mul_f32 v146, v146, v17
    v_mul_f32 v147, v147, v17
    v_mul_f32 v148, v148, v17
    v_mul_f32 v149, v149, v17
    v_mul_f32 v150, v150, v17
    v_mul_f32 v151, v151, v17
    v_mul_f32 v152, v152, v17
    v_mul_f32 v153, v153, v17
    v_mul_f32 v154, v154, v17
    v_mul_f32 v155, v155, v17
    v_mul_f32 v156, v156, v17
    v_mul_f32 v157, v157, v17
    v_mul_f32 v158, v158, v17
    v_mul_f32 v159, v159, v17
    v_mul_f32 v160, v160, v17
    v_mul_f32 v161, v161, v17
    v_mul_f32 v162, v162, v17
    v_mul_f32 v163, v163, v17
    v_mul_f32 v164, v164, v17
    v_mul_f32 v165, v165, v17
    v_mul_f32 v166, v166, v17
    v_mul_f32 v167, v167, v17
    v_mul_f32 v168, v168, v17
    v_mul_f32 v169, v169, v17
    v_mul_f32 v170, v170, v17
    v_mul_f32 v171, v171, v17
    v_mul_f32 v172, v172, v17
    v_mul_f32 v173, v173, v17
    v_mul_f32 v174, v174, v17
    v_mul_f32 v175, v175, v17
    v_mul_f32 v176, v176, v17
    v_mul_f32 v177, v177, v17
    v_mul_f32 v178, v178, v17
    v_mul_f32 v179, v179, v17
    v_mul_f32 v180, v180, v17
    v_mul_f32 v181, v181, v17
    v_mul_f32 v182, v182, v17
    v_mul_f32 v183, v183, v17
    v_mul_f32 v184, v184, v17
    v_mul_f32 v185, v185, v17
    v_mul_f32 v186, v186, v17
    v_mul_f32 v187, v187, v17
    v_mul_f32 v188, v188, v17
    v_mul_f32 v189, v189, v17
    v_mul_f32 v190, v190, v17
    v_mul_f32 v191, v191, v17
    v_mul_f32 v192, v192, v17
    v_mul_f32 v193, v193, v17
    v_mul_f32 v194, v194, v17
    v_mul_f32 v195, v195, v17
    v_mul_f32 v196, v196, v17
    v_mul_f32 v197, v197, v17
    v_mul_f32 v198, v198, v17
    v_mul_f32 v199, v199, v17
    v_mul_f32 v200, v200, v17
    v_mul_f32 v201, v201, v17
    v_mul_f32 v202, v202, v17
    v_mul_f32 v203, v203, v17
    v_mul_f32 v204, v204, v17
    v_mul_f32 v205, v205, v17
    v_mul_f32 v206, v206, v17
    v_mul_f32 v207, v207, v17
    v_mul_f32 v208, v208, v17
    v_mul_f32 v209, v209, v17
    v_mul_f32 v210, v210, v17
    v_mul_f32 v211, v211, v17
    v_mul_f32 v212, v212, v17
    v_mul_f32 v213, v213, v17
    v_mul_f32 v214, v214, v17
    v_mul_f32 v215, v215, v17
    v_mul_f32 v216, v216, v17
    v_mul_f32 v217, v217, v17
    v_mul_f32 v218, v218, v17
    v_mul_f32 v219, v219, v17
    v_mul_f32 v220, v220, v17
    v_mul_f32 v221, v221, v17
    v_mul_f32 v222, v222, v17
    v_mul_f32 v223, v223, v17
    v_mul_f32 v224, v224, v17
    v_mul_f32 v225, v225, v17
    v_mul_f32 v226, v226, v17
    v_mul_f32 v227, v227, v17
    v_mul_f32 v228, v228, v17
    v_mul_f32 v229, v229, v17
    v_mul_f32 v230, v230, v17
    v_mul_f32 v231, v231, v17
    v_mul_f32 v232, v232, v17
    v_mul_f32 v233, v233, v17
    v_mul_f32 v234, v234, v17
    v_mul_f32 v235, v235, v17
    v_mul_f32 v236, v236, v17
    v_mul_f32 v237, v237, v17
    v_mul_f32 v238, v238, v17
    v_mul_f32 v239, v239, v17
    v_mul_f32 v240, v240, v17
    v_mul_f32 v241, v241, v17
    v_mul_f32 v242, v242, v17
    v_mul_f32 v243, v243, v17
    v_mul_f32 v244, v244, v17
    v_mul_f32 v245, v245, v17
    v_mul_f32 v246, v246, v17
    v_mul_f32 v247, v247, v17
    v_mul_f32 v248, v248, v17
    v_mul_f32 v249, v249, v17
    v_mul_f32 v250, v250, v17
    v_mul_f32 v251, v251, v17
    v_mul_f32 v252, v252, v17
    v_mul_f32 v253, v253, v17
    v_mul_f32 v254, v254, v17
    v_mul_f32 v255, v255, v17
    s_nop 1
    s_waitcnt lgkmcnt(10)
    v_mfma_f32_16x16x32_bf16 v[128:131], v[72:75], v[104:107], v[128:131]
    ds_read_b64_tr_b16 v[96:97], v14 offset:192
    ds_read_b64_tr_b16 v[98:99], v14 offset:16832
    s_waitcnt lgkmcnt(10)
    v_mfma_f32_16x16x32_bf16 v[132:135], v[76:79], v[104:107], v[132:135]
    ds_read_b64_tr_b16 v[100:101], v14 offset:224
    ds_read_b64_tr_b16 v[102:103], v14 offset:16864
    s_waitcnt lgkmcnt(10)
    v_mfma_f32_16x16x32_bf16 v[136:139], v[80:83], v[104:107], v[136:139]
    ds_read_b64_tr_b16 v[72:73], v14 offset:256
    ds_read_b64_tr_b16 v[74:75], v14 offset:16896
    s_waitcnt lgkmcnt(10)
    v_mfma_f32_16x16x32_bf16 v[140:143], v[84:87], v[104:107], v[140:143]
    ds_read_b64_tr_b16 v[76:77], v14 offset:288
    ds_read_b64_tr_b16 v[78:79], v14 offset:16928
    s_waitcnt lgkmcnt(10)
    v_mfma_f32_16x16x32_bf16 v[144:147], v[88:91], v[104:107], v[144:147]
    ds_read_b64_tr_b16 v[80:81], v14 offset:320
    ds_read_b64_tr_b16 v[82:83], v14 offset:16960
    s_waitcnt lgkmcnt(10)
    v_mfma_f32_16x16x32_bf16 v[148:151], v[92:95], v[104:107], v[148:151]
    ds_read_b64_tr_b16 v[84:85], v14 offset:352
    ds_read_b64_tr_b16 v[86:87], v14 offset:16992
    s_waitcnt lgkmcnt(10)
    v_mfma_f32_16x16x32_bf16 v[152:155], v[96:99], v[104:107], v[152:155]
    ds_read_b64_tr_b16 v[88:89], v14 offset:384
    ds_read_b64_tr_b16 v[90:91], v14 offset:17024
    s_waitcnt lgkmcnt(10)
    v_mfma_f32_16x16x32_bf16 v[156:159], v[100:103], v[104:107], v[156:159]
    ds_read_b64_tr_b16 v[92:93], v14 offset:416
    ds_read_b64_tr_b16 v[94:95], v14 offset:17056
    s_waitcnt lgkmcnt(10)
    v_mfma_f32_16x16x32_bf16 v[160:163], v[72:75], v[104:107], v[160:163]
    ds_read_b64_tr_b16 v[96:97], v14 offset:448
    ds_read_b64_tr_b16 v[98:99], v14 offset:17088
    s_waitcnt lgkmcnt(10)
    v_mfma_f32_16x16x32_bf16 v[164:167], v[76:79], v[104:107], v[164:167]
    ds_read_b64_tr_b16 v[100:101], v14 offset:480
    ds_read_b64_tr_b16 v[102:103], v14 offset:17120
    s_waitcnt lgkmcnt(10)
    v_mfma_f32_16x16x32_bf16 v[168:171], v[80:83], v[104:107], v[168:171]
    ds_read_b64_tr_b16 v[72:73], v14 offset:512
    ds_read_b64_tr_b16 v[74:75], v14 offset:17152
    s_waitcnt lgkmcnt(10)
    v_mfma_f32_16x16x32_bf16 v[172:175], v[84:87], v[104:107], v[172:175]
    ds_read_b64_tr_b16 v[76:77], v14 offset:544
    ds_read_b64_tr_b16 v[78:79], v14 offset:17184
    s_waitcnt lgkmcnt(10)
    v_mfma_f32_16x16x32_bf16 v[176:179], v[88:91], v[104:107], v[176:179]
    ds_read_b64_tr_b16 v[80:81], v14 offset:576
    ds_read_b64_tr_b16 v[82:83], v14 offset:17216
    s_waitcnt lgkmcnt(10)
    v_mfma_f32_16x16x32_bf16 v[180:183], v[92:95], v[104:107], v[180:183]
    ds_read_b64_tr_b16 v[84:85], v14 offset:608
    ds_read_b64_tr_b16 v[86:87], v14 offset:17248
    s_waitcnt lgkmcnt(10)
    v_mfma_f32_16x16x32_bf16 v[184:187], v[96:99], v[104:107], v[184:187]
    ds_read_b64_tr_b16 v[88:89], v14 offset:640
    ds_read_b64_tr_b16 v[90:91], v14 offset:17280
    s_waitcnt lgkmcnt(10)
    v_mfma_f32_16x16x32_bf16 v[188:191], v[100:103], v[104:107], v[188:191]
    ds_read_b64_tr_b16 v[92:93], v14 offset:672
    ds_read_b64_tr_b16 v[94:95], v14 offset:17312
    s_waitcnt lgkmcnt(10)
    v_mfma_f32_16x16x32_bf16 v[192:195], v[72:75], v[104:107], v[192:195]
    ds_read_b64_tr_b16 v[96:97], v14 offset:704
    ds_read_b64_tr_b16 v[98:99], v14 offset:17344
    s_waitcnt lgkmcnt(10)
    v_mfma_f32_16x16x32_bf16 v[196:199], v[76:79], v[104:107], v[196:199]
    ds_read_b64_tr_b16 v[100:101], v14 offset:736
    ds_read_b64_tr_b16 v[102:103], v14 offset:17376
    s_waitcnt lgkmcnt(10)
    v_mfma_f32_16x16x32_bf16 v[200:203], v[80:83], v[104:107], v[200:203]
    ds_read_b64_tr_b16 v[72:73], v14 offset:768
    ds_read_b64_tr_b16 v[74:75], v14 offset:17408
    s_waitcnt lgkmcnt(10)
    v_mfma_f32_16x16x32_bf16 v[204:207], v[84:87], v[104:107], v[204:207]
    ds_read_b64_tr_b16 v[76:77], v14 offset:800
    ds_read_b64_tr_b16 v[78:79], v14 offset:17440
    s_waitcnt lgkmcnt(10)
    v_mfma_f32_16x16x32_bf16 v[208:211], v[88:91], v[104:107], v[208:211]
    ds_read_b64_tr_b16 v[80:81], v14 offset:832
    ds_read_b64_tr_b16 v[82:83], v14 offset:17472
    s_waitcnt lgkmcnt(10)
    v_mfma_f32_16x16x32_bf16 v[212:215], v[92:95], v[104:107], v[212:215]
    ds_read_b64_tr_b16 v[84:85], v14 offset:864
    ds_read_b64_tr_b16 v[86:87], v14 offset:17504
    s_waitcnt lgkmcnt(10)
    v_mfma_f32_16x16x32_bf16 v[216:219], v[96:99], v[104:107], v[216:219]
    ds_read_b64_tr_b16 v[88:89], v14 offset:896
    ds_read_b64_tr_b16 v[90:91], v14 offset:17536
    s_waitcnt lgkmcnt(10)
    v_mfma_f32_16x16x32_bf16 v[220:223], v[100:103], v[104:107], v[220:223]
    ds_read_b64_tr_b16 v[92:93], v14 offset:928
    ds_read_b64_tr_b16 v[94:95], v14 offset:17568
    s_waitcnt lgkmcnt(10)
    v_mfma_f32_16x16x32_bf16 v[224:227], v[72:75], v[104:107], v[224:227]
    ds_read_b64_tr_b16 v[96:97], v14 offset:960
    ds_read_b64_tr_b16 v[98:99], v14 offset:17600
    s_waitcnt lgkmcnt(10)
    v_mfma_f32_16x16x32_bf16 v[228:231], v[76:79], v[104:107], v[228:231]
    ds_read_b64_tr_b16 v[100:101], v14 offset:992
    ds_read_b64_tr_b16 v[102:103], v14 offset:17632
    s_waitcnt lgkmcnt(10)
    v_mfma_f32_16x16x32_bf16 v[232:235], v[80:83], v[104:107], v[232:235]
    s_waitcnt lgkmcnt(8)
    v_mfma_f32_16x16x32_bf16 v[236:239], v[84:87], v[104:107], v[236:239]
    s_waitcnt lgkmcnt(6)
    v_mfma_f32_16x16x32_bf16 v[240:243], v[88:91], v[104:107], v[240:243]
    s_waitcnt lgkmcnt(4)
    v_mfma_f32_16x16x32_bf16 v[244:247], v[92:95], v[104:107], v[244:247]
    s_waitcnt lgkmcnt(2)
    v_mfma_f32_16x16x32_bf16 v[248:251], v[96:99], v[104:107], v[248:251]
    s_waitcnt lgkmcnt(0)
    v_mfma_f32_16x16x32_bf16 v[252:255], v[100:103], v[104:107], v[252:255]
    s_barrier
    s_add_u32 m0, s45, 0
    s_add_u32 s46, s44, 131072
    buffer_load_dwordx4 v6, s[12:15], s46 offen nt lds
    s_add_u32 s46, s46, 1024
    s_add_u32 m0, m0, 1040
    s_nop 0
    buffer_load_dwordx4 v6, s[12:15], s46 offen nt lds
    s_add_u32 s46, s46, 1024
    s_add_u32 m0, m0, 1040
    s_nop 0
    buffer_load_dwordx4 v6, s[12:15], s46 offen nt lds
    s_add_u32 s46, s46, 1024
    s_add_u32 m0, m0, 1040
    s_nop 0
    buffer_load_dwordx4 v6, s[12:15], s46 offen nt lds
    s_add_u32 s46, s46, 1024
    s_add_u32 m0, m0, 1040
    s_nop 0
    buffer_load_dwordx4 v6, s[12:15], s46 offen nt lds
    s_add_u32 s46, s46, 1024
    s_add_u32 m0, m0, 1040
    s_nop 0
    buffer_load_dwordx4 v6, s[12:15], s46 offen nt lds
    s_add_u32 s46, s46, 1024
    s_add_u32 m0, m0, 1040
    s_nop 0
    buffer_load_dwordx4 v6, s[12:15], s46 offen nt lds
    s_add_u32 s46, s46, 1024
    s_add_u32 m0, m0, 1040
    s_nop 0
    buffer_load_dwordx4 v6, s[12:15], s46 offen nt lds
    s_add_u32 s46, s46, 1024
    s_add_u32 m0, m0, 1040
    s_nop 0
    buffer_load_dwordx4 v6, s[12:15], s46 offen nt lds
    s_add_u32 s46, s46, 1024
    s_add_u32 m0, m0, 1040
    s_nop 0
    buffer_load_dwordx4 v6, s[12:15], s46 offen nt lds
    s_add_u32 s46, s46, 1024
    s_add_u32 m0, m0, 1040
    s_nop 0
    buffer_load_dwordx4 v6, s[12:15], s46 offen nt lds
    s_add_u32 s46, s46, 1024
    s_add_u32 m0, m0, 1040
    s_nop 0
    buffer_load_dwordx4 v6, s[12:15], s46 offen nt lds
    s_add_u32 s46, s46, 1024
    s_add_u32 m0, m0, 1040
    s_nop 0
    buffer_load_dwordx4 v6, s[12:15], s46 offen nt lds
    s_add_u32 s46, s46, 1024
    s_add_u32 m0, m0, 1040
    s_nop 0
    buffer_load_dwordx4 v6, s[12:15], s46 offen nt lds
    s_add_u32 s46, s46, 1024
    s_add_u32 m0, m0, 1040
    s_nop 0
    buffer_load_dwordx4 v6, s[12:15], s46 offen nt lds
    s_add_u32 s46, s46, 1024
    s_add_u32 m0, m0, 1040
    s_nop 0
    buffer_load_dwordx4 v6, s[12:15], s46 offen nt lds
    s_waitcnt vmcnt(16)
    s_barrier
    ds_read_b128 v[40:43], v13 offset:0
    ds_read_b128 v[44:47], v13 offset:16640
    ds_read_b128 v[48:51], v13 offset:64
    ds_read_b128 v[52:55], v13 offset:16704
    ds_read_b128 v[56:59], v13 offset:128
    ds_read_b128 v[60:63], v13 offset:16768
    ds_read_b128 v[64:67], v13 offset:192
    ds_read_b128 v[68:71], v13 offset:16832
    s_waitcnt lgkmcnt(7)
    v_mfma_f32_16x16x32_bf16 v[32:35], v[40:43], a[0:3], 0
    ds_read_b128 v[40:43], v13 offset:256
    s_waitcnt lgkmcnt(7)
    v_mfma_f32_16x16x32_bf16 v[36:39], v[44:47], a[0:3], 0
    ds_read_b128 v[44:47], v13 offset:16896
    s_waitcnt lgkmcnt(7)
    v_mfma_f32_16x16x32_bf16 v[32:35], v[48:51], a[4:7], v[32:35]
    ds_read_b128 v[48:51], v13 offset:320
    s_waitcnt lgkmcnt(7)
    v_mfma_f32_16x16x32_bf16 v[36:39], v[52:55], a[4:7], v[36:39]
    ds_read_b128 v[52:55], v13 offset:16960
    s_waitcnt lgkmcnt(7)
    v_mfma_f32_16x16x32_bf16 v[32:35], v[56:59], a[8:11], v[32:35]
    ds_read_b128 v[56:59], v13 offset:384
    s_waitcnt lgkmcnt(7)
    v_mfma_f32_16x16x32_bf16 v[36:39], v[60:63], a[8:11], v[36:39]
    ds_read_b128 v[60:63], v13 offset:17024
    s_waitcnt lgkmcnt(7)
    v_mfma_f32_16x16x32_bf16 v[32:35], v[64:67], a[12:15], v[32:35]
    ds_read_b128 v[64:67], v13 offset:448
    s_waitcnt lgkmcnt(7)
    v_mfma_f32_16x16x32_bf16 v[36:39], v[68:71], a[12:15], v[36:39]
    ds_read_b128 v[68:71], v13 offset:17088
    s_waitcnt lgkmcnt(7)
    v_mfma_f32_16x16x32_bf16 v[32:35], v[40:43], a[16:19], v[32:35]
    ds_read_b128 v[40:43], v13 offset:512
    s_waitcnt lgkmcnt(7)
    v_mfma_f32_16x16x32_bf16 v[36:39], v[44:47], a[16:19], v[36:39]
    ds_read_b128 v[44:47], v13 offset:17152
    s_waitcnt lgkmcnt(7)
    v_mfma_f32_16x16x32_bf16 v[32:35], v[48:51], a[20:23], v[32:35]
    ds_read_b128 v[48:51], v13 offset:576
    s_waitcnt lgkmcnt(7)
    v_mfma_f32_16x16x32_bf16 v[36:39], v[52:55], a[20:23], v[36:39]
    ds_read_b128 v[52:55], v13 offset:17216
    s_waitcnt lgkmcnt(7)
    v_mfma_f32_16x16x32_bf16 v[32:35], v[56:59], a[24:27], v[32:35]
    ds_read_b128 v[56:59], v13 offset:640
    s_waitcnt lgkmcnt(7)
    v_mfma_f32_16x16x32_bf16 v[36:39], v[60:63], a[24:27], v[36:39]
    ds_read_b128 v[60:63], v13 offset:17280
    s_waitcnt lgkmcnt(7)
    v_mfma_f32_16x16x32_bf16 v[32:35], v[64:67], a[28:31], v[32:35]
    ds_read_b128 v[64:67], v13 offset:704
    s_waitcnt lgkmcnt(7)
    v_mfma_f32_16x16x32_bf16 v[36:39], v[68:71], a[28:31], v[36:39]
    ds_read_b128 v[68:71], v13 offset:17344
    s_waitcnt lgkmcnt(7)
    v_mfma_f32_16x16x32_bf16 v[32:35], v[40:43], a[32:35], v[32:35]
    ds_read_b128 v[40:43], v13 offset:768
    s_waitcnt lgkmcnt(7)
    v_mfma_f32_16x16x32_bf16 v[36:39], v[44:47], a[32:35], v[36:39]
    ds_read_b128 v[44:47], v13 offset:17408
    s_waitcnt lgkmcnt(7)
    v_mfma_f32_16x16x32_bf16 v[32:35], v[48:51], a[36:39], v[32:35]
    ds_read_b128 v[48:51], v13 offset:832
    s_waitcnt lgkmcnt(7)
    v_mfma_f32_16x16x32_bf16 v[36:39], v[52:55], a[36:39], v[36:39]
    ds_read_b128 v[52:55], v13 offset:17472
    s_waitcnt lgkmcnt(7)
    v_mfma_f32_16x16x32_bf16 v[32:35], v[56:59], a[40:43], v[32:35]
    ds_read_b128 v[56:59], v13 offset:896
    s_waitcnt lgkmcnt(7)
    v_mfma_f32_16x16x32_bf16 v[36:39], v[60:63], a[40:43], v[36:39]
    ds_read_b128 v[60:63], v13 offset:17536
    s_waitcnt lgkmcnt(7)
    v_mfma_f32_16x16x32_bf16 v[32:35], v[64:67], a[44:47], v[32:35]
    ds_read_b128 v[64:67], v13 offset:960
    s_waitcnt lgkmcnt(7)
    v_mfma_f32_16x16x32_bf16 v[36:39], v[68:71], a[44:47], v[36:39]
    ds_read_b128 v[68:71], v13 offset:17600
    s_waitcnt lgkmcnt(7)
    v_mfma_f32_16x16x32_bf16 v[32:35], v[40:43], a[48:51], v[32:35]
    s_waitcnt lgkmcnt(6)
    v_mfma_f32_16x16x32_bf16 v[36:39], v[44:47], a[48:51], v[36:39]
    s_waitcnt lgkmcnt(5)
    v_mfma_f32_16x16x32_bf16 v[32:35], v[48:51], a[52:55], v[32:35]
    s_waitcnt lgkmcnt(4)
    v_mfma_f32_16x16x32_bf16 v[36:39], v[52:55], a[52:55], v[36:39]
    s_waitcnt lgkmcnt(3)
    v_mfma_f32_16x16x32_bf16 v[32:35], v[56:59], a[56:59], v[32:35]
    s_waitcnt lgkmcnt(2)
    v_mfma_f32_16x16x32_bf16 v[36:39], v[60:63], a[56:59], v[36:39]
    s_waitcnt lgkmcnt(1)
    v_mfma_f32_16x16x32_bf16 v[32:35], v[64:67], a[60:63], v[32:35]
    s_waitcnt lgkmcnt(0)
    v_mfma_f32_16x16x32_bf16 v[36:39], v[68:71], a[60:63], v[36:39]
    ds_read_b64_tr_b16 v[72:73], v15 offset:0
    ds_read_b64_tr_b16 v[74:75], v15 offset:16640
    ds_read_b64_tr_b16 v[76:77], v15 offset:32
    ds_read_b64_tr_b16 v[78:79], v15 offset:16672
    ds_read_b64_tr_b16 v[80:81], v15 offset:64
    ds_read_b64_tr_b16 v[82:83], v15 offset:16704
    ds_read_b64_tr_b16 v[84:85], v15 offset:96
    ds_read_b64_tr_b16 v[86:87], v15 offset:16736
    ds_read_b64_tr_b16 v[88:89], v15 offset:128
    ds_read_b64_tr_b16 v[90:91], v15 offset:16768
    ds_read_b64_tr_b16 v[92:93], v15 offset:160
    ds_read_b64_tr_b16 v[94:95], v15 offset:16800
    s_nop 3
    v_max3_f32 v16, v32, v33, v34
    v_max3_f32 v16, v16, v35, v36
    v_max3_f32 v16, v16, v37, v38
    v_max_f32 v16, v16, v39
    v_mov_b32 v17, v16
    s_nop 1
    v_permlane16_swap_b32 v16, v17
    s_nop 1
    v_max_f32 v16, v16, v17
    v_mov_b32 v17, v16
    s_nop 1
    v_permlane32_swap_b32 v16, v17
    s_nop 1
    v_max_f32 v16, v16, v17
    v_max_f32 v16, v16, v10
    v_sub_f32 v17, v10, v16
    v_mul_f32 v17, s33, v17
    v_exp_f32 v17, v17
    v_mov_b32 v10, v16
    v_mul_f32 v16, s33, v16
    v_fma_f32 v32, v32, s33, -v16
    v_fma_f32 v33, v33, s33, -v16
    v_fma_f32 v34, v34, s33, -v16
    v_fma_f32 v35, v35, s33, -v16
    v_fma_f32 v36, v36, s33, -v16
    v_fma_f32 v37, v37, s33, -v16
    v_fma_f32 v38, v38, s33, -v16
    v_fma_f32 v39, v39, s33, -v16
    v_exp_f32 v32, v32
    v_exp_f32 v33, v33
    v_exp_f32 v34, v34
    v_exp_f32 v35, v35
    v_exp_f32 v36, v36
    v_exp_f32 v37, v37
    v_exp_f32 v38, v38
    v_exp_f32 v39, v39
    v_mul_f32 v11, v11, v17
    v_add_f32 v11, v11, v32
    v_add_f32 v11, v11, v33
    v_add_f32 v11, v11, v34
    v_add_f32 v11, v11, v35
    v_add_f32 v11, v11, v36
    v_add_f32 v11, v11, v37
    v_add_f32 v11, v11, v38
    v_add_f32 v11, v11, v39
    v_cvt_pk_bf16_f32 v104, v32, v33
    v_cvt_pk_bf16_f32 v105, v34, v35
    v_cvt_pk_bf16_f32 v106, v36, v37
    v_cvt_pk_bf16_f32 v107, v38, v39
    v_mul_f32 v128, v128, v17
    v_mul_f32 v129, v129, v17
    v_mul_f32 v130, v130, v17
    v_mul_f32 v131, v131, v17
    v_mul_f32 v132, v132, v17
    v_mul_f32 v133, v133, v17
    v_mul_f32 v134, v134, v17
    v_mul_f32 v135, v135, v17
    v_mul_f32 v136, v136, v17
    v_mul_f32 v137, v137, v17
    v_mul_f32 v138, v138, v17
    v_mul_f32 v139, v139, v17
    v_mul_f32 v140, v140, v17
    v_mul_f32 v141, v141, v17
    v_mul_f32 v142, v142, v17
    v_mul_f32 v143, v143, v17
    v_mul_f32 v144, v144, v17
    v_mul_f32 v145, v145, v17
    v_mul_f32 v146, v146, v17
    v_mul_f32 v147, v147, v17
    v_mul_f32 v148, v148, v17
    v_mul_f32 v149, v149, v17
    v_mul_f32 v150, v150, v17
    v_mul_f32 v151, v151, v17
    v_mul_f32 v152, v152, v17
    v_mul_f32 v153, v153, v17
    v_mul_f32 v154, v154, v17
    v_mul_f32 v155, v155, v17
    v_mul_f32 v156, v156, v17
    v_mul_f32 v157, v157, v17
    v_mul_f32 v158, v158, v17
    v_mul_f32 v159, v159, v17
    v_mul_f32 v160, v160, v17
    v_mul_f32 v161, v161, v17
    v_mul_f32 v162, v162, v17
    v_mul_f32 v163, v163, v17
    v_mul_f32 v164, v164, v17
    v_mul_f32 v165, v165, v17
    v_mul_f32 v166, v166, v17
    v_mul_f32 v167, v167, v17
    v_mul_f32 v168, v168, v17
    v_mul_f32 v169, v169, v17
    v_mul_f32 v170, v170, v17
    v_mul_f32 v171, v171, v17
    v_mul_f32 v172, v172, v17
    v_mul_f32 v173, v173, v17
    v_mul_f32 v174, v174, v17
    v_mul_f32 v175, v175, v17
    v_mul_f32 v176, v176, v17
    v_mul_f32 v177, v177, v17
    v_mul_f32 v178, v178, v17
    v_mul_f32 v179, v179, v17
    v_mul_f32 v180, v180, v17
    v_mul_f32 v181, v181, v17
    v_mul_f32 v182, v182, v17
    v_mul_f32 v183, v183, v17
    v_mul_f32 v184, v184, v17
    v_mul_f32 v185, v185, v17
    v_mul_f32 v186, v186, v17
    v_mul_f32 v187, v187, v17
    v_mul_f32 v188, v188, v17
    v_mul_f32 v189, v189, v17
    v_mul_f32 v190, v190, v17
    v_mul_f32 v191, v191, v17
    v_mul_f32 v192, v192, v17
    v_mul_f32 v193, v193, v17
    v_mul_f32 v194, v194, v17
    v_mul_f32 v195, v195, v17
    v_mul_f32 v196, v196, v17
    v_mul_f32 v197, v197, v17
    v_mul_f32 v198, v198, v17
    v_mul_f32 v199, v199, v17
    v_mul_f32 v200, v200, v17
    v_mul_f32 v201, v201, v17
    v_mul_f32 v202, v202, v17
    v_mul_f32 v203, v203, v17
    v_mul_f32 v204, v204, v17
    v_mul_f32 v205, v205, v17
    v_mul_f32 v206, v206, v17
    v_mul_f32 v207, v207, v17
    v_mul_f32 v208, v208, v17
    v_mul_f32 v209, v209, v17
    v_mul_f32 v210, v210, v17
    v_mul_f32 v211, v211, v17
    v_mul_f32 v212, v212, v17
    v_mul_f32 v213, v213, v17
    v_mul_f32 v214, v214, v17
    v_mul_f32 v215, v215, v17
    v_mul_f32 v216, v216, v17
    v_mul_f32 v217, v217, v17
    v_mul_f32 v218, v218, v17
    v_mul_f32 v219, v219, v17
    v_mul_f32 v220, v220, v17
    v_mul_f32 v221, v221, v17
    v_mul_f32 v222, v222, v17
    v_mul_f32 v223, v223, v17
    v_mul_f32 v224, v224, v17
    v_mul_f32 v225, v225, v17
    v_mul_f32 v226, v226, v17
    v_mul_f32 v227, v227, v17
    v_mul_f32 v228, v228, v17
    v_mul_f32 v229, v229, v17
    v_mul_f32 v230, v230, v17
    v_mul_f32 v231, v231, v17
    v_mul_f32 v232, v232, v17
    v_mul_f32 v233, v233, v17
    v_mul_f32 v234, v234, v17
    v_mul_f32 v235, v235, v17
    v_mul_f32 v236, v236, v17
    v_mul_f32 v237, v237, v17
    v_mul_f32 v238, v238, v17
    v_mul_f32 v239, v239, v17
    v_mul_f32 v240, v240, v17
    v_mul_f32 v241, v241, v17
    v_mul_f32 v242, v242, v17
    v_mul_f32 v243, v243, v17
    v_mul_f32 v244, v244, v17
    v_mul_f32 v245, v245, v17
    v_mul_f32 v246, v246, v17
    v_mul_f32 v247, v247, v17
    v_mul_f32 v248, v248, v17
    v_mul_f32 v249, v249, v17
    v_mul_f32 v250, v250, v17
    v_mul_f32 v251, v251, v17
    v_mul_f32 v252, v252, v17
    v_mul_f32 v253, v253, v17
    v_mul_f32 v254, v254, v17
    v_mul_f32 v255, v255, v17
    s_nop 1
    s_waitcnt lgkmcnt(10)
    v_mfma_f32_16x16x32_bf16 v[128:131], v[72:75], v[104:107], v[128:131]
    ds_read_b64_tr_b16 v[96:97], v15 offset:192
    ds_read_b64_tr_b16 v[98:99], v15 offset:16832
    s_waitcnt lgkmcnt(10)
    v_mfma_f32_16x16x32_bf16 v[132:135], v[76:79], v[104:107], v[132:135]
    ds_read_b64_tr_b16 v[100:101], v15 offset:224
    ds_read_b64_tr_b16 v[102:103], v15 offset:16864
    s_waitcnt lgkmcnt(10)
    v_mfma_f32_16x16x32_bf16 v[136:139], v[80:83], v[104:107], v[136:139]
    ds_read_b64_tr_b16 v[72:73], v15 offset:256
    ds_read_b64_tr_b16 v[74:75], v15 offset:16896
    s_waitcnt lgkmcnt(10)
    v_mfma_f32_16x16x32_bf16 v[140:143], v[84:87], v[104:107], v[140:143]
    ds_read_b64_tr_b16 v[76:77], v15 offset:288
    ds_read_b64_tr_b16 v[78:79], v15 offset:16928
    s_waitcnt lgkmcnt(10)
    v_mfma_f32_16x16x32_bf16 v[144:147], v[88:91], v[104:107], v[144:147]
    ds_read_b64_tr_b16 v[80:81], v15 offset:320
    ds_read_b64_tr_b16 v[82:83], v15 offset:16960
    s_waitcnt lgkmcnt(10)
    v_mfma_f32_16x16x32_bf16 v[148:151], v[92:95], v[104:107], v[148:151]
    ds_read_b64_tr_b16 v[84:85], v15 offset:352
    ds_read_b64_tr_b16 v[86:87], v15 offset:16992
    s_waitcnt lgkmcnt(10)
    v_mfma_f32_16x16x32_bf16 v[152:155], v[96:99], v[104:107], v[152:155]
    ds_read_b64_tr_b16 v[88:89], v15 offset:384
    ds_read_b64_tr_b16 v[90:91], v15 offset:17024
    s_waitcnt lgkmcnt(10)
    v_mfma_f32_16x16x32_bf16 v[156:159], v[100:103], v[104:107], v[156:159]
    ds_read_b64_tr_b16 v[92:93], v15 offset:416
    ds_read_b64_tr_b16 v[94:95], v15 offset:17056
    s_waitcnt lgkmcnt(10)
    v_mfma_f32_16x16x32_bf16 v[160:163], v[72:75], v[104:107], v[160:163]
    ds_read_b64_tr_b16 v[96:97], v15 offset:448
    ds_read_b64_tr_b16 v[98:99], v15 offset:17088
    s_waitcnt lgkmcnt(10)
    v_mfma_f32_16x16x32_bf16 v[164:167], v[76:79], v[104:107], v[164:167]
    ds_read_b64_tr_b16 v[100:101], v15 offset:480
    ds_read_b64_tr_b16 v[102:103], v15 offset:17120
    s_waitcnt lgkmcnt(10)
    v_mfma_f32_16x16x32_bf16 v[168:171], v[80:83], v[104:107], v[168:171]
    ds_read_b64_tr_b16 v[72:73], v15 offset:512
    ds_read_b64_tr_b16 v[74:75], v15 offset:17152
    s_waitcnt lgkmcnt(10)
    v_mfma_f32_16x16x32_bf16 v[172:175], v[84:87], v[104:107], v[172:175]
    ds_read_b64_tr_b16 v[76:77], v15 offset:544
    ds_read_b64_tr_b16 v[78:79], v15 offset:17184
    s_waitcnt lgkmcnt(10)
    v_mfma_f32_16x16x32_bf16 v[176:179], v[88:91], v[104:107], v[176:179]
    ds_read_b64_tr_b16 v[80:81], v15 offset:576
    ds_read_b64_tr_b16 v[82:83], v15 offset:17216
    s_waitcnt lgkmcnt(10)
    v_mfma_f32_16x16x32_bf16 v[180:183], v[92:95], v[104:107], v[180:183]
    ds_read_b64_tr_b16 v[84:85], v15 offset:608
    ds_read_b64_tr_b16 v[86:87], v15 offset:17248
    s_waitcnt lgkmcnt(10)
    v_mfma_f32_16x16x32_bf16 v[184:187], v[96:99], v[104:107], v[184:187]
    ds_read_b64_tr_b16 v[88:89], v15 offset:640
    ds_read_b64_tr_b16 v[90:91], v15 offset:17280
    s_waitcnt lgkmcnt(10)
    v_mfma_f32_16x16x32_bf16 v[188:191], v[100:103], v[104:107], v[188:191]
    ds_read_b64_tr_b16 v[92:93], v15 offset:672
    ds_read_b64_tr_b16 v[94:95], v15 offset:17312
    s_waitcnt lgkmcnt(10)
    v_mfma_f32_16x16x32_bf16 v[192:195], v[72:75], v[104:107], v[192:195]
    ds_read_b64_tr_b16 v[96:97], v15 offset:704
    ds_read_b64_tr_b16 v[98:99], v15 offset:17344
    s_waitcnt lgkmcnt(10)
    v_mfma_f32_16x16x32_bf16 v[196:199], v[76:79], v[104:107], v[196:199]
    ds_read_b64_tr_b16 v[100:101], v15 offset:736
    ds_read_b64_tr_b16 v[102:103], v15 offset:17376
    s_waitcnt lgkmcnt(10)
    v_mfma_f32_16x16x32_bf16 v[200:203], v[80:83], v[104:107], v[200:203]
    ds_read_b64_tr_b16 v[72:73], v15 offset:768
    ds_read_b64_tr_b16 v[74:75], v15 offset:17408
    s_waitcnt lgkmcnt(10)
    v_mfma_f32_16x16x32_bf16 v[204:207], v[84:87], v[104:107], v[204:207]
    ds_read_b64_tr_b16 v[76:77], v15 offset:800
    ds_read_b64_tr_b16 v[78:79], v15 offset:17440
    s_waitcnt lgkmcnt(10)
    v_mfma_f32_16x16x32_bf16 v[208:211], v[88:91], v[104:107], v[208:211]
    ds_read_b64_tr_b16 v[80:81], v15 offset:832
    ds_read_b64_tr_b16 v[82:83], v15 offset:17472
    s_waitcnt lgkmcnt(10)
    v_mfma_f32_16x16x32_bf16 v[212:215], v[92:95], v[104:107], v[212:215]
    ds_read_b64_tr_b16 v[84:85], v15 offset:864
    ds_read_b64_tr_b16 v[86:87], v15 offset:17504
    s_waitcnt lgkmcnt(10)
    v_mfma_f32_16x16x32_bf16 v[216:219], v[96:99], v[104:107], v[216:219]
    ds_read_b64_tr_b16 v[88:89], v15 offset:896
    ds_read_b64_tr_b16 v[90:91], v15 offset:17536
    s_waitcnt lgkmcnt(10)
    v_mfma_f32_16x16x32_bf16 v[220:223], v[100:103], v[104:107], v[220:223]
    ds_read_b64_tr_b16 v[92:93], v15 offset:928
    ds_read_b64_tr_b16 v[94:95], v15 offset:17568
    s_waitcnt lgkmcnt(10)
    v_mfma_f32_16x16x32_bf16 v[224:227], v[72:75], v[104:107], v[224:227]
    ds_read_b64_tr_b16 v[96:97], v15 offset:960
    ds_read_b64_tr_b16 v[98:99], v15 offset:17600
    s_waitcnt lgkmcnt(10)
    v_mfma_f32_16x16x32_bf16 v[228:231], v[76:79], v[104:107], v[228:231]
    ds_read_b64_tr_b16 v[100:101], v15 offset:992
    ds_read_b64_tr_b16 v[102:103], v15 offset:17632
    s_waitcnt lgkmcnt(10)
    v_mfma_f32_16x16x32_bf16 v[232:235], v[80:83], v[104:107], v[232:235]
    s_waitcnt lgkmcnt(8)
    v_mfma_f32_16x16x32_bf16 v[236:239], v[84:87], v[104:107], v[236:239]
    s_waitcnt lgkmcnt(6)
    v_mfma_f32_16x16x32_bf16 v[240:243], v[88:91], v[104:107], v[240:243]
    s_waitcnt lgkmcnt(4)
    v_mfma_f32_16x16x32_bf16 v[244:247], v[92:95], v[104:107], v[244:247]
    s_waitcnt lgkmcnt(2)
    v_mfma_f32_16x16x32_bf16 v[248:251], v[96:99], v[104:107], v[248:251]
    s_waitcnt lgkmcnt(0)
    v_mfma_f32_16x16x32_bf16 v[252:255], v[100:103], v[104:107], v[252:255]
    s_barrier
    s_add_u32 m0, s45, 66560
    s_add_u32 s46, s44, 196608
    buffer_load_dwordx4 v6, s[12:15], s46 offen nt lds
    s_add_u32 s46, s46, 1024
    s_add_u32 m0, m0, 1040
    s_nop 0
    buffer_load_dwordx4 v6, s[12:15], s46 offen nt lds
    s_add_u32 s46, s46, 1024
    s_add_u32 m0, m0, 1040
    s_nop 0
    buffer_load_dwordx4 v6, s[12:15], s46 offen nt lds
    s_add_u32 s46, s46, 1024
    s_add_u32 m0, m0, 1040
    s_nop 0
    buffer_load_dwordx4 v6, s[12:15], s46 offen nt lds
    s_add_u32 s46, s46, 1024
    s_add_u32 m0, m0, 1040
    s_nop 0
    buffer_load_dwordx4 v6, s[12:15], s46 offen nt lds
    s_add_u32 s46, s46, 1024
    s_add_u32 m0, m0, 1040
    s_nop 0
    buffer_load_dwordx4 v6, s[12:15], s46 offen nt lds
    s_add_u32 s46, s46, 1024
    s_add_u32 m0, m0, 1040
    s_nop 0
    buffer_load_dwordx4 v6, s[12:15], s46 offen nt lds
    s_add_u32 s46, s46, 1024
    s_add_u32 m0, m0, 1040
    s_nop 0
    buffer_load_dwordx4 v6, s[12:15], s46 offen nt lds
    s_add_u32 s46, s46, 1024
    s_add_u32 m0, m0, 1040
    s_nop 0
    buffer_load_dwordx4 v6, s[12:15], s46 offen nt lds
    s_add_u32 s46, s46, 1024
    s_add_u32 m0, m0, 1040
    s_nop 0
    buffer_load_dwordx4 v6, s[12:15], s46 offen nt lds
    s_add_u32 s46, s46, 1024
    s_add_u32 m0, m0, 1040
    s_nop 0
    buffer_load_dwordx4 v6, s[12:15], s46 offen nt lds
    s_add_u32 s46, s46, 1024
    s_add_u32 m0, m0, 1040
    s_nop 0
    buffer_load_dwordx4 v6, s[12:15], s46 offen nt lds
    s_add_u32 s46, s46, 1024
    s_add_u32 m0, m0, 1040
    s_nop 0
    buffer_load_dwordx4 v6, s[12:15], s46 offen nt lds
    s_add_u32 s46, s46, 1024
    s_add_u32 m0, m0, 1040
    s_nop 0
    buffer_load_dwordx4 v6, s[12:15], s46 offen nt lds
    s_add_u32 s46, s46, 1024
    s_add_u32 m0, m0, 1040
    s_nop 0
    buffer_load_dwordx4 v6, s[12:15], s46 offen nt lds
    s_add_u32 s46, s46, 1024
    s_add_u32 m0, m0, 1040
    s_nop 0
    buffer_load_dwordx4 v6, s[12:15], s46 offen nt lds
    s_waitcnt vmcnt(16)
    s_barrier
    ds_read_b128 v[40:43], v12 offset:0
    ds_read_b128 v[44:47], v12 offset:16640
    ds_read_b128 v[48:51], v12 offset:64
    ds_read_b128 v[52:55], v12 offset:16704
    ds_read_b128 v[56:59], v12 offset:128
    ds_read_b128 v[60:63], v12 offset:16768
    ds_read_b128 v[64:67], v12 offset:192
    ds_read_b128 v[68:71], v12 offset:16832
    s_waitcnt lgkmcnt(7)
    v_mfma_f32_16x16x32_bf16 v[32:35], v[40:43], a[0:3], 0
    ds_read_b128 v[40:43], v12 offset:256
    s_waitcnt lgkmcnt(7)
    v_mfma_f32_16x16x32_bf16 v[36:39], v[44:47], a[0:3], 0
    ds_read_b128 v[44:47], v12 offset:16896
    s_waitcnt lgkmcnt(7)
    v_mfma_f32_16x16x32_bf16 v[32:35], v[48:51], a[4:7], v[32:35]
    ds_read_b128 v[48:51], v12 offset:320
    s_waitcnt lgkmcnt(7)
    v_mfma_f32_16x16x32_bf16 v[36:39], v[52:55], a[4:7], v[36:39]
    ds_read_b128 v[52:55], v12 offset:16960
    s_waitcnt lgkmcnt(7)
    v_mfma_f32_16x16x32_bf16 v[32:35], v[56:59], a[8:11], v[32:35]
    ds_read_b128 v[56:59], v12 offset:384
    s_waitcnt lgkmcnt(7)
    v_mfma_f32_16x16x32_bf16 v[36:39], v[60:63], a[8:11], v[36:39]
    ds_read_b128 v[60:63], v12 offset:17024
    s_waitcnt lgkmcnt(7)
    v_mfma_f32_16x16x32_bf16 v[32:35], v[64:67], a[12:15], v[32:35]
    ds_read_b128 v[64:67], v12 offset:448
    s_waitcnt lgkmcnt(7)
    v_mfma_f32_16x16x32_bf16 v[36:39], v[68:71], a[12:15], v[36:39]
    ds_read_b128 v[68:71], v12 offset:17088
    s_waitcnt lgkmcnt(7)
    v_mfma_f32_16x16x32_bf16 v[32:35], v[40:43], a[16:19], v[32:35]
    ds_read_b128 v[40:43], v12 offset:512
    s_waitcnt lgkmcnt(7)
    v_mfma_f32_16x16x32_bf16 v[36:39], v[44:47], a[16:19], v[36:39]
    ds_read_b128 v[44:47], v12 offset:17152
    s_waitcnt lgkmcnt(7)
    v_mfma_f32_16x16x32_bf16 v[32:35], v[48:51], a[20:23], v[32:35]
    ds_read_b128 v[48:51], v12 offset:576
    s_waitcnt lgkmcnt(7)
    v_mfma_f32_16x16x32_bf16 v[36:39], v[52:55], a[20:23], v[36:39]
    ds_read_b128 v[52:55], v12 offset:17216
    s_waitcnt lgkmcnt(7)
    v_mfma_f32_16x16x32_bf16 v[32:35], v[56:59], a[24:27], v[32:35]
    ds_read_b128 v[56:59], v12 offset:640
    s_waitcnt lgkmcnt(7)
    v_mfma_f32_16x16x32_bf16 v[36:39], v[60:63], a[24:27], v[36:39]
    ds_read_b128 v[60:63], v12 offset:17280
    s_waitcnt lgkmcnt(7)
    v_mfma_f32_16x16x32_bf16 v[32:35], v[64:67], a[28:31], v[32:35]
    ds_read_b128 v[64:67], v12 offset:704
    s_waitcnt lgkmcnt(7)
    v_mfma_f32_16x16x32_bf16 v[36:39], v[68:71], a[28:31], v[36:39]
    ds_read_b128 v[68:71], v12 offset:17344
    s_waitcnt lgkmcnt(7)
    v_mfma_f32_16x16x32_bf16 v[32:35], v[40:43], a[32:35], v[32:35]
    ds_read_b128 v[40:43], v12 offset:768
    s_waitcnt lgkmcnt(7)
    v_mfma_f32_16x16x32_bf16 v[36:39], v[44:47], a[32:35], v[36:39]
    ds_read_b128 v[44:47], v12 offset:17408
    s_waitcnt lgkmcnt(7)
    v_mfma_f32_16x16x32_bf16 v[32:35], v[48:51], a[36:39], v[32:35]
    ds_read_b128 v[48:51], v12 offset:832
    s_waitcnt lgkmcnt(7)
    v_mfma_f32_16x16x32_bf16 v[36:39], v[52:55], a[36:39], v[36:39]
    ds_read_b128 v[52:55], v12 offset:17472
    s_waitcnt lgkmcnt(7)
    v_mfma_f32_16x16x32_bf16 v[32:35], v[56:59], a[40:43], v[32:35]
    ds_read_b128 v[56:59], v12 offset:896
    s_waitcnt lgkmcnt(7)
    v_mfma_f32_16x16x32_bf16 v[36:39], v[60:63], a[40:43], v[36:39]
    ds_read_b128 v[60:63], v12 offset:17536
    s_waitcnt lgkmcnt(7)
    v_mfma_f32_16x16x32_bf16 v[32:35], v[64:67], a[44:47], v[32:35]
    ds_read_b128 v[64:67], v12 offset:960
    s_waitcnt lgkmcnt(7)
    v_mfma_f32_16x16x32_bf16 v[36:39], v[68:71], a[44:47], v[36:39]
    ds_read_b128 v[68:71], v12 offset:17600
    s_waitcnt lgkmcnt(7)
    v_mfma_f32_16x16x32_bf16 v[32:35], v[40:43], a[48:51], v[32:35]
    s_waitcnt lgkmcnt(6)
    v_mfma_f32_16x16x32_bf16 v[36:39], v[44:47], a[48:51], v[36:39]
    s_waitcnt lgkmcnt(5)
    v_mfma_f32_16x16x32_bf16 v[32:35], v[48:51], a[52:55], v[32:35]
    s_waitcnt lgkmcnt(4)
    v_mfma_f32_16x16x32_bf16 v[36:39], v[52:55], a[52:55], v[36:39]
    s_waitcnt lgkmcnt(3)
    v_mfma_f32_16x16x32_bf16 v[32:35], v[56:59], a[56:59], v[32:35]
    s_waitcnt lgkmcnt(2)
    v_mfma_f32_16x16x32_bf16 v[36:39], v[60:63], a[56:59], v[36:39]
    s_waitcnt lgkmcnt(1)
    v_mfma_f32_16x16x32_bf16 v[32:35], v[64:67], a[60:63], v[32:35]
    s_waitcnt lgkmcnt(0)
    v_mfma_f32_16x16x32_bf16 v[36:39], v[68:71], a[60:63], v[36:39]
    ds_read_b64_tr_b16 v[72:73], v14 offset:0
    ds_read_b64_tr_b16 v[74:75], v14 offset:16640
    ds_read_b64_tr_b16 v[76:77], v14 offset:32
    ds_read_b64_tr_b16 v[78:79], v14 offset:16672
    ds_read_b64_tr_b16 v[80:81], v14 offset:64
    ds_read_b64_tr_b16 v[82:83], v14 offset:16704
    ds_read_b64_tr_b16 v[84:85], v14 offset:96
    ds_read_b64_tr_b16 v[86:87], v14 offset:16736
    ds_read_b64_tr_b16 v[88:89], v14 offset:128
    ds_read_b64_tr_b16 v[90:91], v14 offset:16768
    ds_read_b64_tr_b16 v[92:93], v14 offset:160
    ds_read_b64_tr_b16 v[94:95], v14 offset:16800
    s_nop 3
    v_max3_f32 v16, v32, v33, v34
    v_max3_f32 v16, v16, v35, v36
    v_max3_f32 v16, v16, v37, v38
    v_max_f32 v16, v16, v39
    v_mov_b32 v17, v16
    s_nop 1
    v_permlane16_swap_b32 v16, v17
    s_nop 1
    v_max_f32 v16, v16, v17
    v_mov_b32 v17, v16
    s_nop 1
    v_permlane32_swap_b32 v16, v17
    s_nop 1
    v_max_f32 v16, v16, v17
    v_max_f32 v16, v16, v10
    v_sub_f32 v17, v10, v16
    v_mul_f32 v17, s33, v17
    v_exp_f32 v17, v17
    v_mov_b32 v10, v16
    v_mul_f32 v16, s33, v16
    v_fma_f32 v32, v32, s33, -v16
    v_fma_f32 v33, v33, s33, -v16
    v_fma_f32 v34, v34, s33, -v16
    v_fma_f32 v35, v35, s33, -v16
    v_fma_f32 v36, v36, s33, -v16
    v_fma_f32 v37, v37, s33, -v16
    v_fma_f32 v38, v38, s33, -v16
    v_fma_f32 v39, v39, s33, -v16
    v_exp_f32 v32, v32
    v_exp_f32 v33, v33
    v_exp_f32 v34, v34
    v_exp_f32 v35, v35
    v_exp_f32 v36, v36
    v_exp_f32 v37, v37
    v_exp_f32 v38, v38
    v_exp_f32 v39, v39
    v_mul_f32 v11, v11, v17
    v_add_f32 v11, v11, v32
    v_add_f32 v11, v11, v33
    v_add_f32 v11, v11, v34
    v_add_f32 v11, v11, v35
    v_add_f32 v11, v11, v36
    v_add_f32 v11, v11, v37
    v_add_f32 v11, v11, v38
    v_add_f32 v11, v11, v39
    v_cvt_pk_bf16_f32 v104, v32, v33
    v_cvt_pk_bf16_f32 v105, v34, v35
    v_cvt_pk_bf16_f32 v106, v36, v37
    v_cvt_pk_bf16_f32 v107, v38, v39
    v_mul_f32 v128, v128, v17
    v_mul_f32 v129, v129, v17
    v_mul_f32 v130, v130, v17
    v_mul_f32 v131, v131, v17
    v_mul_f32 v132, v132, v17
    v_mul_f32 v133, v133, v17
    v_mul_f32 v134, v134, v17
    v_mul_f32 v135, v135, v17
    v_mul_f32 v136, v136, v17
    v_mul_f32 v137, v137, v17
    v_mul_f32 v138, v138, v17
    v_mul_f32 v139, v139, v17
    v_mul_f32 v140, v140, v17
    v_mul_f32 v141, v141, v17
    v_mul_f32 v142, v142, v17
    v_mul_f32 v143, v143, v17
    v_mul_f32 v144, v144, v17
    v_mul_f32 v145, v145, v17
    v_mul_f32 v146, v146, v17
    v_mul_f32 v147, v147, v17
    v_mul_f32 v148, v148, v17
    v_mul_f32 v149, v149, v17
    v_mul_f32 v150, v150, v17
    v_mul_f32 v151, v151, v17
    v_mul_f32 v152, v152, v17
    v_mul_f32 v153, v153, v17
    v_mul_f32 v154, v154, v17
    v_mul_f32 v155, v155, v17
    v_mul_f32 v156, v156, v17
    v_mul_f32 v157, v157, v17
    v_mul_f32 v158, v158, v17
    v_mul_f32 v159, v159, v17
    v_mul_f32 v160, v160, v17
    v_mul_f32 v161, v161, v17
    v_mul_f32 v162, v162, v17
    v_mul_f32 v163, v163, v17
    v_mul_f32 v164, v164, v17
    v_mul_f32 v165, v165, v17
    v_mul_f32 v166, v166, v17
    v_mul_f32 v167, v167, v17
    v_mul_f32 v168, v168, v17
    v_mul_f32 v169, v169, v17
    v_mul_f32 v170, v170, v17
    v_mul_f32 v171, v171, v17
    v_mul_f32 v172, v172, v17
    v_mul_f32 v173, v173, v17
    v_mul_f32 v174, v174, v17
    v_mul_f32 v175, v175, v17
    v_mul_f32 v176, v176, v17
    v_mul_f32 v177, v177, v17
    v_mul_f32 v178, v178, v17
    v_mul_f32 v179, v179, v17
    v_mul_f32 v180, v180, v17
    v_mul_f32 v181, v181, v17
    v_mul_f32 v182, v182, v17
    v_mul_f32 v183, v183, v17
    v_mul_f32 v184, v184, v17
    v_mul_f32 v185, v185, v17
    v_mul_f32 v186, v186, v17
    v_mul_f32 v187, v187, v17
    v_mul_f32 v188, v188, v17
    v_mul_f32 v189, v189, v17
    v_mul_f32 v190, v190, v17
    v_mul_f32 v191, v191, v17
    v_mul_f32 v192, v192, v17
    v_mul_f32 v193, v193, v17
    v_mul_f32 v194, v194, v17
    v_mul_f32 v195, v195, v17
    v_mul_f32 v196, v196, v17
    v_mul_f32 v197, v197, v17
    v_mul_f32 v198, v198, v17
    v_mul_f32 v199, v199, v17
    v_mul_f32 v200, v200, v17
    v_mul_f32 v201, v201, v17
    v_mul_f32 v202, v202, v17
    v_mul_f32 v203, v203, v17
    v_mul_f32 v204, v204, v17
    v_mul_f32 v205, v205, v17
    v_mul_f32 v206, v206, v17
    v_mul_f32 v207, v207, v17
    v_mul_f32 v208, v208, v17
    v_mul_f32 v209, v209, v17
    v_mul_f32 v210, v210, v17
    v_mul_f32 v211, v211, v17
    v_mul_f32 v212, v212, v17
    v_mul_f32 v213, v213, v17
    v_mul_f32 v214, v214, v17
    v_mul_f32 v215, v215, v17
    v_mul_f32 v216, v216, v17
    v_mul_f32 v217, v217, v17
    v_mul_f32 v218, v218, v17
    v_mul_f32 v219, v219, v17
    v_mul_f32 v220, v220, v17
    v_mul_f32 v221, v221, v17
    v_mul_f32 v222, v222, v17
    v_mul_f32 v223, v223, v17
    v_mul_f32 v224, v224, v17
    v_mul_f32 v225, v225, v17
    v_mul_f32 v226, v226, v17
    v_mul_f32 v227, v227, v17
    v_mul_f32 v228, v228, v17
    v_mul_f32 v229, v229, v17
    v_mul_f32 v230, v230, v17
    v_mul_f32 v231, v231, v17
    v_mul_f32 v232, v232, v17
    v_mul_f32 v233, v233, v17
    v_mul_f32 v234, v234, v17
    v_mul_f32 v235, v235, v17
    v_mul_f32 v236, v236, v17
    v_mul_f32 v237, v237, v17
    v_mul_f32 v238, v238, v17
    v_mul_f32 v239, v239, v17
    v_mul_f32 v240, v240, v17
    v_mul_f32 v241, v241, v17
    v_mul_f32 v242, v242, v17
    v_mul_f32 v243, v243, v17
    v_mul_f32 v244, v244, v17
    v_mul_f32 v245, v245, v17
    v_mul_f32 v246, v246, v17
    v_mul_f32 v247, v247, v17
    v_mul_f32 v248, v248, v17
    v_mul_f32 v249, v249, v17
    v_mul_f32 v250, v250, v17
    v_mul_f32 v251, v251, v17
    v_mul_f32 v252, v252, v17
    v_mul_f32 v253, v253, v17
    v_mul_f32 v254, v254, v17
    v_mul_f32 v255, v255, v17
    s_nop 1
    s_waitcnt lgkmcnt(10)
    v_mfma_f32_16x16x32_bf16 v[128:131], v[72:75], v[104:107], v[128:131]
    ds_read_b64_tr_b16 v[96:97], v14 offset:192
    ds_read_b64_tr_b16 v[98:99], v14 offset:16832
    s_waitcnt lgkmcnt(10)
    v_mfma_f32_16x16x32_bf16 v[132:135], v[76:79], v[104:107], v[132:135]
    ds_read_b64_tr_b16 v[100:101], v14 offset:224
    ds_read_b64_tr_b16 v[102:103], v14 offset:16864
    s_waitcnt lgkmcnt(10)
    v_mfma_f32_16x16x32_bf16 v[136:139], v[80:83], v[104:107], v[136:139]
    ds_read_b64_tr_b16 v[72:73], v14 offset:256
    ds_read_b64_tr_b16 v[74:75], v14 offset:16896
    s_waitcnt lgkmcnt(10)
    v_mfma_f32_16x16x32_bf16 v[140:143], v[84:87], v[104:107], v[140:143]
    ds_read_b64_tr_b16 v[76:77], v14 offset:288
    ds_read_b64_tr_b16 v[78:79], v14 offset:16928
    s_waitcnt lgkmcnt(10)
    v_mfma_f32_16x16x32_bf16 v[144:147], v[88:91], v[104:107], v[144:147]
    ds_read_b64_tr_b16 v[80:81], v14 offset:320
    ds_read_b64_tr_b16 v[82:83], v14 offset:16960
    s_waitcnt lgkmcnt(10)
    v_mfma_f32_16x16x32_bf16 v[148:151], v[92:95], v[104:107], v[148:151]
    ds_read_b64_tr_b16 v[84:85], v14 offset:352
    ds_read_b64_tr_b16 v[86:87], v14 offset:16992
    s_waitcnt lgkmcnt(10)
    v_mfma_f32_16x16x32_bf16 v[152:155], v[96:99], v[104:107], v[152:155]
    ds_read_b64_tr_b16 v[88:89], v14 offset:384
    ds_read_b64_tr_b16 v[90:91], v14 offset:17024
    s_waitcnt lgkmcnt(10)
    v_mfma_f32_16x16x32_bf16 v[156:159], v[100:103], v[104:107], v[156:159]
    ds_read_b64_tr_b16 v[92:93], v14 offset:416
    ds_read_b64_tr_b16 v[94:95], v14 offset:17056
    s_waitcnt lgkmcnt(10)
    v_mfma_f32_16x16x32_bf16 v[160:163], v[72:75], v[104:107], v[160:163]
    ds_read_b64_tr_b16 v[96:97], v14 offset:448
    ds_read_b64_tr_b16 v[98:99], v14 offset:17088
    s_waitcnt lgkmcnt(10)
    v_mfma_f32_16x16x32_bf16 v[164:167], v[76:79], v[104:107], v[164:167]
    ds_read_b64_tr_b16 v[100:101], v14 offset:480
    ds_read_b64_tr_b16 v[102:103], v14 offset:17120
    s_waitcnt lgkmcnt(10)
    v_mfma_f32_16x16x32_bf16 v[168:171], v[80:83], v[104:107], v[168:171]
    ds_read_b64_tr_b16 v[72:73], v14 offset:512
    ds_read_b64_tr_b16 v[74:75], v14 offset:17152
    s_waitcnt lgkmcnt(10)
    v_mfma_f32_16x16x32_bf16 v[172:175], v[84:87], v[104:107], v[172:175]
    ds_read_b64_tr_b16 v[76:77], v14 offset:544
    ds_read_b64_tr_b16 v[78:79], v14 offset:17184
    s_waitcnt lgkmcnt(10)
    v_mfma_f32_16x16x32_bf16 v[176:179], v[88:91], v[104:107], v[176:179]
    ds_read_b64_tr_b16 v[80:81], v14 offset:576
    ds_read_b64_tr_b16 v[82:83], v14 offset:17216
    s_waitcnt lgkmcnt(10)
    v_mfma_f32_16x16x32_bf16 v[180:183], v[92:95], v[104:107], v[180:183]
    ds_read_b64_tr_b16 v[84:85], v14 offset:608
    ds_read_b64_tr_b16 v[86:87], v14 offset:17248
    s_waitcnt lgkmcnt(10)
    v_mfma_f32_16x16x32_bf16 v[184:187], v[96:99], v[104:107], v[184:187]
    ds_read_b64_tr_b16 v[88:89], v14 offset:640
    ds_read_b64_tr_b16 v[90:91], v14 offset:17280
    s_waitcnt lgkmcnt(10)
    v_mfma_f32_16x16x32_bf16 v[188:191], v[100:103], v[104:107], v[188:191]
    ds_read_b64_tr_b16 v[92:93], v14 offset:672
    ds_read_b64_tr_b16 v[94:95], v14 offset:17312
    s_waitcnt lgkmcnt(10)
    v_mfma_f32_16x16x32_bf16 v[192:195], v[72:75], v[104:107], v[192:195]
    ds_read_b64_tr_b16 v[96:97], v14 offset:704
    ds_read_b64_tr_b16 v[98:99], v14 offset:17344
    s_waitcnt lgkmcnt(10)
    v_mfma_f32_16x16x32_bf16 v[196:199], v[76:79], v[104:107], v[196:199]
    ds_read_b64_tr_b16 v[100:101], v14 offset:736
    ds_read_b64_tr_b16 v[102:103], v14 offset:17376
    s_waitcnt lgkmcnt(10)
    v_mfma_f32_16x16x32_bf16 v[200:203], v[80:83], v[104:107], v[200:203]
    ds_read_b64_tr_b16 v[72:73], v14 offset:768
    ds_read_b64_tr_b16 v[74:75], v14 offset:17408
    s_waitcnt lgkmcnt(10)
    v_mfma_f32_16x16x32_bf16 v[204:207], v[84:87], v[104:107], v[204:207]
    ds_read_b64_tr_b16 v[76:77], v14 offset:800
    ds_read_b64_tr_b16 v[78:79], v14 offset:17440
    s_waitcnt lgkmcnt(10)
    v_mfma_f32_16x16x32_bf16 v[208:211], v[88:91], v[104:107], v[208:211]
    ds_read_b64_tr_b16 v[80:81], v14 offset:832
    ds_read_b64_tr_b16 v[82:83], v14 offset:17472
    s_waitcnt lgkmcnt(10)
    v_mfma_f32_16x16x32_bf16 v[212:215], v[92:95], v[104:107], v[212:215]
    ds_read_b64_tr_b16 v[84:85], v14 offset:864
    ds_read_b64_tr_b16 v[86:87], v14 offset:17504
    s_waitcnt lgkmcnt(10)
    v_mfma_f32_16x16x32_bf16 v[216:219], v[96:99], v[104:107], v[216:219]
    ds_read_b64_tr_b16 v[88:89], v14 offset:896
    ds_read_b64_tr_b16 v[90:91], v14 offset:17536
    s_waitcnt lgkmcnt(10)
    v_mfma_f32_16x16x32_bf16 v[220:223], v[100:103], v[104:107], v[220:223]
    ds_read_b64_tr_b16 v[92:93], v14 offset:928
    ds_read_b64_tr_b16 v[94:95], v14 offset:17568
    s_waitcnt lgkmcnt(10)
    v_mfma_f32_16x16x32_bf16 v[224:227], v[72:75], v[104:107], v[224:227]
    ds_read_b64_tr_b16 v[96:97], v14 offset:960
    ds_read_b64_tr_b16 v[98:99], v14 offset:17600
    s_waitcnt lgkmcnt(10)
    v_mfma_f32_16x16x32_bf16 v[228:231], v[76:79], v[104:107], v[228:231]
    ds_read_b64_tr_b16 v[100:101], v14 offset:992
    ds_read_b64_tr_b16 v[102:103], v14 offset:17632
    s_waitcnt lgkmcnt(10)
    v_mfma_f32_16x16x32_bf16 v[232:235], v[80:83], v[104:107], v[232:235]
    s_waitcnt lgkmcnt(8)
    v_mfma_f32_16x16x32_bf16 v[236:239], v[84:87], v[104:107], v[236:239]
    s_waitcnt lgkmcnt(6)
    v_mfma_f32_16x16x32_bf16 v[240:243], v[88:91], v[104:107], v[240:243]
    s_waitcnt lgkmcnt(4)
    v_mfma_f32_16x16x32_bf16 v[244:247], v[92:95], v[104:107], v[244:247]
    s_waitcnt lgkmcnt(2)
    v_mfma_f32_16x16x32_bf16 v[248:251], v[96:99], v[104:107], v[248:251]
    s_waitcnt lgkmcnt(0)
    v_mfma_f32_16x16x32_bf16 v[252:255], v[100:103], v[104:107], v[252:255]
    s_barrier
    s_waitcnt vmcnt(0)
    s_barrier
    ds_read_b128 v[40:43], v13 offset:0
    ds_read_b128 v[44:47], v13 offset:16640
    ds_read_b128 v[48:51], v13 offset:64
    ds_read_b128 v[52:55], v13 offset:16704
    ds_read_b128 v[56:59], v13 offset:128
    ds_read_b128 v[60:63], v13 offset:16768
    ds_read_b128 v[64:67], v13 offset:192
    ds_read_b128 v[68:71], v13 offset:16832
    s_waitcnt lgkmcnt(7)
    v_mfma_f32_16x16x32_bf16 v[32:35], v[40:43], a[0:3], 0
    ds_read_b128 v[40:43], v13 offset:256
    s_waitcnt lgkmcnt(7)
    v_mfma_f32_16x16x32_bf16 v[36:39], v[44:47], a[0:3], 0
    ds_read_b128 v[44:47], v13 offset:16896
    s_waitcnt lgkmcnt(7)
    v_mfma_f32_16x16x32_bf16 v[32:35], v[48:51], a[4:7], v[32:35]
    ds_read_b128 v[48:51], v13 offset:320
    s_waitcnt lgkmcnt(7)
    v_mfma_f32_16x16x32_bf16 v[36:39], v[52:55], a[4:7], v[36:39]
    ds_read_b128 v[52:55], v13 offset:16960
    s_waitcnt lgkmcnt(7)
    v_mfma_f32_16x16x32_bf16 v[32:35], v[56:59], a[8:11], v[32:35]
    ds_read_b128 v[56:59], v13 offset:384
    s_waitcnt lgkmcnt(7)
    v_mfma_f32_16x16x32_bf16 v[36:39], v[60:63], a[8:11], v[36:39]
    ds_read_b128 v[60:63], v13 offset:17024
    s_waitcnt lgkmcnt(7)
    v_mfma_f32_16x16x32_bf16 v[32:35], v[64:67], a[12:15], v[32:35]
    ds_read_b128 v[64:67], v13 offset:448
    s_waitcnt lgkmcnt(7)
    v_mfma_f32_16x16x32_bf16 v[36:39], v[68:71], a[12:15], v[36:39]
    ds_read_b128 v[68:71], v13 offset:17088
    s_waitcnt lgkmcnt(7)
    v_mfma_f32_16x16x32_bf16 v[32:35], v[40:43], a[16:19], v[32:35]
    ds_read_b128 v[40:43], v13 offset:512
    s_waitcnt lgkmcnt(7)
    v_mfma_f32_16x16x32_bf16 v[36:39], v[44:47], a[16:19], v[36:39]
    ds_read_b128 v[44:47], v13 offset:17152
    s_waitcnt lgkmcnt(7)
    v_mfma_f32_16x16x32_bf16 v[32:35], v[48:51], a[20:23], v[32:35]
    ds_read_b128 v[48:51], v13 offset:576
    s_waitcnt lgkmcnt(7)
    v_mfma_f32_16x16x32_bf16 v[36:39], v[52:55], a[20:23], v[36:39]
    ds_read_b128 v[52:55], v13 offset:17216
    s_waitcnt lgkmcnt(7)
    v_mfma_f32_16x16x32_bf16 v[32:35], v[56:59], a[24:27], v[32:35]
    ds_read_b128 v[56:59], v13 offset:640
    s_waitcnt lgkmcnt(7)
    v_mfma_f32_16x16x32_bf16 v[36:39], v[60:63], a[24:27], v[36:39]
    ds_read_b128 v[60:63], v13 offset:17280
    s_waitcnt lgkmcnt(7)
    v_mfma_f32_16x16x32_bf16 v[32:35], v[64:67], a[28:31], v[32:35]
    ds_read_b128 v[64:67], v13 offset:704
    s_waitcnt lgkmcnt(7)
    v_mfma_f32_16x16x32_bf16 v[36:39], v[68:71], a[28:31], v[36:39]
    ds_read_b128 v[68:71], v13 offset:17344
    s_waitcnt lgkmcnt(7)
    v_mfma_f32_16x16x32_bf16 v[32:35], v[40:43], a[32:35], v[32:35]
    ds_read_b128 v[40:43], v13 offset:768
    s_waitcnt lgkmcnt(7)
    v_mfma_f32_16x16x32_bf16 v[36:39], v[44:47], a[32:35], v[36:39]
    ds_read_b128 v[44:47], v13 offset:17408
    s_waitcnt lgkmcnt(7)
    v_mfma_f32_16x16x32_bf16 v[32:35], v[48:51], a[36:39], v[32:35]
    ds_read_b128 v[48:51], v13 offset:832
    s_waitcnt lgkmcnt(7)
    v_mfma_f32_16x16x32_bf16 v[36:39], v[52:55], a[36:39], v[36:39]
    ds_read_b128 v[52:55], v13 offset:17472
    s_waitcnt lgkmcnt(7)
    v_mfma_f32_16x16x32_bf16 v[32:35], v[56:59], a[40:43], v[32:35]
    ds_read_b128 v[56:59], v13 offset:896
    s_waitcnt lgkmcnt(7)
    v_mfma_f32_16x16x32_bf16 v[36:39], v[60:63], a[40:43], v[36:39]
    ds_read_b128 v[60:63], v13 offset:17536
    s_waitcnt lgkmcnt(7)
    v_mfma_f32_16x16x32_bf16 v[32:35], v[64:67], a[44:47], v[32:35]
    ds_read_b128 v[64:67], v13 offset:960
    s_waitcnt lgkmcnt(7)
    v_mfma_f32_16x16x32_bf16 v[36:39], v[68:71], a[44:47], v[36:39]
    ds_read_b128 v[68:71], v13 offset:17600
    s_waitcnt lgkmcnt(7)
    v_mfma_f32_16x16x32_bf16 v[32:35], v[40:43], a[48:51], v[32:35]
    s_waitcnt lgkmcnt(6)
    v_mfma_f32_16x16x32_bf16 v[36:39], v[44:47], a[48:51], v[36:39]
    s_waitcnt lgkmcnt(5)
    v_mfma_f32_16x16x32_bf16 v[32:35], v[48:51], a[52:55], v[32:35]
    s_waitcnt lgkmcnt(4)
    v_mfma_f32_16x16x32_bf16 v[36:39], v[52:55], a[52:55], v[36:39]
    s_waitcnt lgkmcnt(3)
    v_mfma_f32_16x16x32_bf16 v[32:35], v[56:59], a[56:59], v[32:35]
    s_waitcnt lgkmcnt(2)
    v_mfma_f32_16x16x32_bf16 v[36:39], v[60:63], a[56:59], v[36:39]
    s_waitcnt lgkmcnt(1)
    v_mfma_f32_16x16x32_bf16 v[32:35], v[64:67], a[60:63], v[32:35]
    s_waitcnt lgkmcnt(0)
    v_mfma_f32_16x16x32_bf16 v[36:39], v[68:71], a[60:63], v[36:39]
    ds_read_b64_tr_b16 v[72:73], v15 offset:0
    ds_read_b64_tr_b16 v[74:75], v15 offset:16640
    ds_read_b64_tr_b16 v[76:77], v15 offset:32
    ds_read_b64_tr_b16 v[78:79], v15 offset:16672
    ds_read_b64_tr_b16 v[80:81], v15 offset:64
    ds_read_b64_tr_b16 v[82:83], v15 offset:16704
    ds_read_b64_tr_b16 v[84:85], v15 offset:96
    ds_read_b64_tr_b16 v[86:87], v15 offset:16736
    ds_read_b64_tr_b16 v[88:89], v15 offset:128
    ds_read_b64_tr_b16 v[90:91], v15 offset:16768
    ds_read_b64_tr_b16 v[92:93], v15 offset:160
    ds_read_b64_tr_b16 v[94:95], v15 offset:16800
    s_nop 3
    v_max3_f32 v16, v32, v33, v34
    v_max3_f32 v16, v16, v35, v36
    v_max3_f32 v16, v16, v37, v38
    v_max_f32 v16, v16, v39
    v_mov_b32 v17, v16
    s_nop 1
    v_permlane16_swap_b32 v16, v17
    s_nop 1
    v_max_f32 v16, v16, v17
    v_mov_b32 v17, v16
    s_nop 1
    v_permlane32_swap_b32 v16, v17
    s_nop 1
    v_max_f32 v16, v16, v17
    v_max_f32 v16, v16, v10
    v_sub_f32 v17, v10, v16
    v_mul_f32 v17, s33, v17
    v_exp_f32 v17, v17
    v_mov_b32 v10, v16
    v_mul_f32 v16, s33, v16
    v_fma_f32 v32, v32, s33, -v16
    v_fma_f32 v33, v33, s33, -v16
    v_fma_f32 v34, v34, s33, -v16
    v_fma_f32 v35, v35, s33, -v16
    v_fma_f32 v36, v36, s33, -v16
    v_fma_f32 v37, v37, s33, -v16
    v_fma_f32 v38, v38, s33, -v16
    v_fma_f32 v39, v39, s33, -v16
    v_exp_f32 v32, v32
    v_exp_f32 v33, v33
    v_exp_f32 v34, v34
    v_exp_f32 v35, v35
    v_exp_f32 v36, v36
    v_exp_f32 v37, v37
    v_exp_f32 v38, v38
    v_exp_f32 v39, v39
    v_mul_f32 v11, v11, v17
    v_add_f32 v11, v11, v32
    v_add_f32 v11, v11, v33
    v_add_f32 v11, v11, v34
    v_add_f32 v11, v11, v35
    v_add_f32 v11, v11, v36
    v_add_f32 v11, v11, v37
    v_add_f32 v11, v11, v38
    v_add_f32 v11, v11, v39
    v_cvt_pk_bf16_f32 v104, v32, v33
    v_cvt_pk_bf16_f32 v105, v34, v35
    v_cvt_pk_bf16_f32 v106, v36, v37
    v_cvt_pk_bf16_f32 v107, v38, v39
    v_mul_f32 v128, v128, v17
    v_mul_f32 v129, v129, v17
    v_mul_f32 v130, v130, v17
    v_mul_f32 v131, v131, v17
    v_mul_f32 v132, v132, v17
    v_mul_f32 v133, v133, v17
    v_mul_f32 v134, v134, v17
    v_mul_f32 v135, v135, v17
    v_mul_f32 v136, v136, v17
    v_mul_f32 v137, v137, v17
    v_mul_f32 v138, v138, v17
    v_mul_f32 v139, v139, v17
    v_mul_f32 v140, v140, v17
    v_mul_f32 v141, v141, v17
    v_mul_f32 v142, v142, v17
    v_mul_f32 v143, v143, v17
    v_mul_f32 v144, v144, v17
    v_mul_f32 v145, v145, v17
    v_mul_f32 v146, v146, v17
    v_mul_f32 v147, v147, v17
    v_mul_f32 v148, v148, v17
    v_mul_f32 v149, v149, v17
    v_mul_f32 v150, v150, v17
    v_mul_f32 v151, v151, v17
    v_mul_f32 v152, v152, v17
    v_mul_f32 v153, v153, v17
    v_mul_f32 v154, v154, v17
    v_mul_f32 v155, v155, v17
    v_mul_f32 v156, v156, v17
    v_mul_f32 v157, v157, v17
    v_mul_f32 v158, v158, v17
    v_mul_f32 v159, v159, v17
    v_mul_f32 v160, v160, v17
    v_mul_f32 v161, v161, v17
    v_mul_f32 v162, v162, v17
    v_mul_f32 v163, v163, v17
    v_mul_f32 v164, v164, v17
    v_mul_f32 v165, v165, v17
    v_mul_f32 v166, v166, v17
    v_mul_f32 v167, v167, v17
    v_mul_f32 v168, v168, v17
    v_mul_f32 v169, v169, v17
    v_mul_f32 v170, v170, v17
    v_mul_f32 v171, v171, v17
    v_mul_f32 v172, v172, v17
    v_mul_f32 v173, v173, v17
    v_mul_f32 v174, v174, v17
    v_mul_f32 v175, v175, v17
    v_mul_f32 v176, v176, v17
    v_mul_f32 v177, v177, v17
    v_mul_f32 v178, v178, v17
    v_mul_f32 v179, v179, v17
    v_mul_f32 v180, v180, v17
    v_mul_f32 v181, v181, v17
    v_mul_f32 v182, v182, v17
    v_mul_f32 v183, v183, v17
    v_mul_f32 v184, v184, v17
    v_mul_f32 v185, v185, v17
    v_mul_f32 v186, v186, v17
    v_mul_f32 v187, v187, v17
    v_mul_f32 v188, v188, v17
    v_mul_f32 v189, v189, v17
    v_mul_f32 v190, v190, v17
    v_mul_f32 v191, v191, v17
    v_mul_f32 v192, v192, v17
    v_mul_f32 v193, v193, v17
    v_mul_f32 v194, v194, v17
    v_mul_f32 v195, v195, v17
    v_mul_f32 v196, v196, v17
    v_mul_f32 v197, v197, v17
    v_mul_f32 v198, v198, v17
    v_mul_f32 v199, v199, v17
    v_mul_f32 v200, v200, v17
    v_mul_f32 v201, v201, v17
    v_mul_f32 v202, v202, v17
    v_mul_f32 v203, v203, v17
    v_mul_f32 v204, v204, v17
    v_mul_f32 v205, v205, v17
    v_mul_f32 v206, v206, v17
    v_mul_f32 v207, v207, v17
    v_mul_f32 v208, v208, v17
    v_mul_f32 v209, v209, v17
    v_mul_f32 v210, v210, v17
    v_mul_f32 v211, v211, v17
    v_mul_f32 v212, v212, v17
    v_mul_f32 v213, v213, v17
    v_mul_f32 v214, v214, v17
    v_mul_f32 v215, v215, v17
    v_mul_f32 v216, v216, v17
    v_mul_f32 v217, v217, v17
    v_mul_f32 v218, v218, v17
    v_mul_f32 v219, v219, v17
    v_mul_f32 v220, v220, v17
    v_mul_f32 v221, v221, v17
    v_mul_f32 v222, v222, v17
    v_mul_f32 v223, v223, v17
    v_mul_f32 v224, v224, v17
    v_mul_f32 v225, v225, v17
    v_mul_f32 v226, v226, v17
    v_mul_f32 v227, v227, v17
    v_mul_f32 v228, v228, v17
    v_mul_f32 v229, v229, v17
    v_mul_f32 v230, v230, v17
    v_mul_f32 v231, v231, v17
    v_mul_f32 v232, v232, v17
    v_mul_f32 v233, v233, v17
    v_mul_f32 v234, v234, v17
    v_mul_f32 v235, v235, v17
    v_mul_f32 v236, v236, v17
    v_mul_f32 v237, v237, v17
    v_mul_f32 v238, v238, v17
    v_mul_f32 v239, v239, v17
    v_mul_f32 v240, v240, v17
    v_mul_f32 v241, v241, v17
    v_mul_f32 v242, v242, v17
    v_mul_f32 v243, v243, v17
    v_mul_f32 v244, v244, v17
    v_mul_f32 v245, v245, v17
    v_mul_f32 v246, v246, v17
    v_mul_f32 v247, v247, v17
    v_mul_f32 v248, v248, v17
    v_mul_f32 v249, v249, v17
    v_mul_f32 v250, v250, v17
    v_mul_f32 v251, v251, v17
    v_mul_f32 v252, v252, v17
    v_mul_f32 v253, v253, v17
    v_mul_f32 v254, v254, v17
    v_mul_f32 v255, v255, v17
    s_nop 1
    s_waitcnt lgkmcnt(10)
    v_mfma_f32_16x16x32_bf16 v[128:131], v[72:75], v[104:107], v[128:131]
    ds_read_b64_tr_b16 v[96:97], v15 offset:192
    ds_read_b64_tr_b16 v[98:99], v15 offset:16832
    s_waitcnt lgkmcnt(10)
    v_mfma_f32_16x16x32_bf16 v[132:135], v[76:79], v[104:107], v[132:135]
    ds_read_b64_tr_b16 v[100:101], v15 offset:224
    ds_read_b64_tr_b16 v[102:103], v15 offset:16864
    s_waitcnt lgkmcnt(10)
    v_mfma_f32_16x16x32_bf16 v[136:139], v[80:83], v[104:107], v[136:139]
    ds_read_b64_tr_b16 v[72:73], v15 offset:256
    ds_read_b64_tr_b16 v[74:75], v15 offset:16896
    s_waitcnt lgkmcnt(10)
    v_mfma_f32_16x16x32_bf16 v[140:143], v[84:87], v[104:107], v[140:143]
    ds_read_b64_tr_b16 v[76:77], v15 offset:288
    ds_read_b64_tr_b16 v[78:79], v15 offset:16928
    s_waitcnt lgkmcnt(10)
    v_mfma_f32_16x16x32_bf16 v[144:147], v[88:91], v[104:107], v[144:147]
    ds_read_b64_tr_b16 v[80:81], v15 offset:320
    ds_read_b64_tr_b16 v[82:83], v15 offset:16960
    s_waitcnt lgkmcnt(10)
    v_mfma_f32_16x16x32_bf16 v[148:151], v[92:95], v[104:107], v[148:151]
    ds_read_b64_tr_b16 v[84:85], v15 offset:352
    ds_read_b64_tr_b16 v[86:87], v15 offset:16992
    s_waitcnt lgkmcnt(10)
    v_mfma_f32_16x16x32_bf16 v[152:155], v[96:99], v[104:107], v[152:155]
    ds_read_b64_tr_b16 v[88:89], v15 offset:384
    ds_read_b64_tr_b16 v[90:91], v15 offset:17024
    s_waitcnt lgkmcnt(10)
    v_mfma_f32_16x16x32_bf16 v[156:159], v[100:103], v[104:107], v[156:159]
    ds_read_b64_tr_b16 v[92:93], v15 offset:416
    ds_read_b64_tr_b16 v[94:95], v15 offset:17056
    s_waitcnt lgkmcnt(10)
    v_mfma_f32_16x16x32_bf16 v[160:163], v[72:75], v[104:107], v[160:163]
    ds_read_b64_tr_b16 v[96:97], v15 offset:448
    ds_read_b64_tr_b16 v[98:99], v15 offset:17088
    s_waitcnt lgkmcnt(10)
    v_mfma_f32_16x16x32_bf16 v[164:167], v[76:79], v[104:107], v[164:167]
    ds_read_b64_tr_b16 v[100:101], v15 offset:480
    ds_read_b64_tr_b16 v[102:103], v15 offset:17120
    s_waitcnt lgkmcnt(10)
    v_mfma_f32_16x16x32_bf16 v[168:171], v[80:83], v[104:107], v[168:171]
    ds_read_b64_tr_b16 v[72:73], v15 offset:512
    ds_read_b64_tr_b16 v[74:75], v15 offset:17152
    s_waitcnt lgkmcnt(10)
    v_mfma_f32_16x16x32_bf16 v[172:175], v[84:87], v[104:107], v[172:175]
    ds_read_b64_tr_b16 v[76:77], v15 offset:544
    ds_read_b64_tr_b16 v[78:79], v15 offset:17184
    s_waitcnt lgkmcnt(10)
    v_mfma_f32_16x16x32_bf16 v[176:179], v[88:91], v[104:107], v[176:179]
    ds_read_b64_tr_b16 v[80:81], v15 offset:576
    ds_read_b64_tr_b16 v[82:83], v15 offset:17216
    s_waitcnt lgkmcnt(10)
    v_mfma_f32_16x16x32_bf16 v[180:183], v[92:95], v[104:107], v[180:183]
    ds_read_b64_tr_b16 v[84:85], v15 offset:608
    ds_read_b64_tr_b16 v[86:87], v15 offset:17248
    s_waitcnt lgkmcnt(10)
    v_mfma_f32_16x16x32_bf16 v[184:187], v[96:99], v[104:107], v[184:187]
    ds_read_b64_tr_b16 v[88:89], v15 offset:640
    ds_read_b64_tr_b16 v[90:91], v15 offset:17280
    s_waitcnt lgkmcnt(10)
    v_mfma_f32_16x16x32_bf16 v[188:191], v[100:103], v[104:107], v[188:191]
    ds_read_b64_tr_b16 v[92:93], v15 offset:672
    ds_read_b64_tr_b16 v[94:95], v15 offset:17312
    s_waitcnt lgkmcnt(10)
    v_mfma_f32_16x16x32_bf16 v[192:195], v[72:75], v[104:107], v[192:195]
    ds_read_b64_tr_b16 v[96:97], v15 offset:704
    ds_read_b64_tr_b16 v[98:99], v15 offset:17344
    s_waitcnt lgkmcnt(10)
    v_mfma_f32_16x16x32_bf16 v[196:199], v[76:79], v[104:107], v[196:199]
    ds_read_b64_tr_b16 v[100:101], v15 offset:736
    ds_read_b64_tr_b16 v[102:103], v15 offset:17376
    s_waitcnt lgkmcnt(10)
    v_mfma_f32_16x16x32_bf16 v[200:203], v[80:83], v[104:107], v[200:203]
    ds_read_b64_tr_b16 v[72:73], v15 offset:768
    ds_read_b64_tr_b16 v[74:75], v15 offset:17408
    s_waitcnt lgkmcnt(10)
    v_mfma_f32_16x16x32_bf16 v[204:207], v[84:87], v[104:107], v[204:207]
    ds_read_b64_tr_b16 v[76:77], v15 offset:800
    ds_read_b64_tr_b16 v[78:79], v15 offset:17440
    s_waitcnt lgkmcnt(10)
    v_mfma_f32_16x16x32_bf16 v[208:211], v[88:91], v[104:107], v[208:211]
    ds_read_b64_tr_b16 v[80:81], v15 offset:832
    ds_read_b64_tr_b16 v[82:83], v15 offset:17472
    s_waitcnt lgkmcnt(10)
    v_mfma_f32_16x16x32_bf16 v[212:215], v[92:95], v[104:107], v[212:215]
    ds_read_b64_tr_b16 v[84:85], v15 offset:864
    ds_read_b64_tr_b16 v[86:87], v15 offset:17504
    s_waitcnt lgkmcnt(10)
    v_mfma_f32_16x16x32_bf16 v[216:219], v[96:99], v[104:107], v[216:219]
    ds_read_b64_tr_b16 v[88:89], v15 offset:896
    ds_read_b64_tr_b16 v[90:91], v15 offset:17536
    s_waitcnt lgkmcnt(10)
    v_mfma_f32_16x16x32_bf16 v[220:223], v[100:103], v[104:107], v[220:223]
    ds_read_b64_tr_b16 v[92:93], v15 offset:928
    ds_read_b64_tr_b16 v[94:95], v15 offset:17568
    s_waitcnt lgkmcnt(10)
    v_mfma_f32_16x16x32_bf16 v[224:227], v[72:75], v[104:107], v[224:227]
    ds_read_b64_tr_b16 v[96:97], v15 offset:960
    ds_read_b64_tr_b16 v[98:99], v15 offset:17600
    s_waitcnt lgkmcnt(10)
    v_mfma_f32_16x16x32_bf16 v[228:231], v[76:79], v[104:107], v[228:231]
    ds_read_b64_tr_b16 v[100:101], v15 offset:992
    ds_read_b64_tr_b16 v[102:103], v15 offset:17632
    s_waitcnt lgkmcnt(10)
    v_mfma_f32_16x16x32_bf16 v[232:235], v[80:83], v[104:107], v[232:235]
    s_waitcnt lgkmcnt(8)
    v_mfma_f32_16x16x32_bf16 v[236:239], v[84:87], v[104:107], v[236:239]
    s_waitcnt lgkmcnt(6)
    v_mfma_f32_16x16x32_bf16 v[240:243], v[88:91], v[104:107], v[240:243]
    s_waitcnt lgkmcnt(4)
    v_mfma_f32_16x16x32_bf16 v[244:247], v[92:95], v[104:107], v[244:247]
    s_waitcnt lgkmcnt(2)
    v_mfma_f32_16x16x32_bf16 v[248:251], v[96:99], v[104:107], v[248:251]
    s_waitcnt lgkmcnt(0)
    v_mfma_f32_16x16x32_bf16 v[252:255], v[100:103], v[104:107], v[252:255]
    s_nop 7
    s_nop 3
    v_mov_b32 v17, v11
    s_nop 1
    v_permlane16_swap_b32 v11, v17
    s_nop 1
    v_add_f32 v11, v11, v17
    v_mov_b32 v17, v11
    s_nop 1
    v_permlane32_swap_b32 v11, v17
    s_nop 1
    v_add_f32 v11, v11, v17
    s_barrier
    v_lshlrev_b32 v16, 4, v1
    s_lshl_b32 s47, s42, 15
    v_add_u32 v16, s47, v16
    s_lshl_b32 s46, s42, 9
    v_lshlrev_b32 v18, 3, v1
    v_add_u32 v18, s46, v18
    s_cmp_eq_u32 s43, 0
    s_cbranch_scc1 Lk2b_recv
    ds_write_b128 v16, v[128:131] offset:0
    ds_write_b128 v16, v[132:135] offset:1024
    ds_write_b128 v16, v[136:139] offset:2048
    ds_write_b128 v16, v[140:143] offset:3072
    ds_write_b128 v16, v[144:147] offset:4096
    ds_write_b128 v16, v[148:151] offset:5120
    ds_write_b128 v16, v[152:155] offset:6144
    ds_write_b128 v16, v[156:159] offset:7168
    ds_write_b128 v16, v[160:163] offset:8192
    ds_write_b128 v16, v[164:167] offset:9216
    ds_write_b128 v16, v[168:171] offset:10240
    ds_write_b128 v16, v[172:175] offset:11264
    ds_write_b128 v16, v[176:179] offset:12288
    ds_write_b128 v16, v[180:183] offset:13312
    ds_write_b128 v16, v[184:187] offset:14336
    ds_write_b128 v16, v[188:191] offset:15360
    ds_write_b128 v16, v[192:195] offset:16384
    ds_write_b128 v16, v[196:199] offset:17408
    ds_write_b128 v16, v[200:203] offset:18432
    ds_write_b128 v16, v[204:207] offset:19456
    ds_write_b128 v16, v[208:211] offset:20480
    ds_write_b128 v16, v[212:215] offset:21504
    ds_write_b128 v16, v[216:219] offset:22528
    ds_write_b128 v16, v[220:223] offset:23552
    ds_write_b128 v16, v[224:227] offset:24576
    ds_write_b128 v16, v[228:231] offset:25600
    ds_write_b128 v16, v[232:235] offset:26624
    ds_write_b128 v16, v[236:239] offset:27648
    ds_write_b128 v16, v[240:243] offset:28672
    ds_write_b128 v16, v[244:247] offset:29696
    ds_write_b128 v16, v[248:251] offset:30720
    ds_write_b128 v16, v[252:255] offset:31744
    v_add_u32 v18, 65536, v18
    ds_write_b64 v18, v[10:11]
    s_waitcnt lgkmcnt(0)
    s_barrier
    s_endpgm
Lk2b_recv:
    s_barrier
    v_add_u32 v18, 65536, v18
    ds_read_b64 v[20:21], v18
    s_waitcnt lgkmcnt(0)
    v_max_f32 v22, v10, v20
    v_sub_f32 v23, v10, v22
    v_sub_f32 v24, v20, v22
    v_mul_f32 v23, s33, v23
    v_mul_f32 v24, s33, v24
    v_exp_f32 v23, v23
    v_exp_f32 v24, v24
    s_nop 0
    v_mul_f32 v11, v11, v23
    v_fma_f32 v11, v21, v24, v11
    v_mul_f32 v10, s33, v22
    v_lshlrev_b32 v19, 11, v3
    v_lshl_add_u32 v19, v2, 4, v19
    s_lshl_b32 s46, s3, 16
    s_lshl_b32 s47, s42, 15
    s_add_u32 s46, s46, s47
    s_add_u32 s46, s46, 0x100000
    ds_read_b128 v[40:43], v16 offset:0
    ds_read_b128 v[44:47], v16 offset:1024
    ds_read_b128 v[48:51], v16 offset:2048
    ds_read_b128 v[52:55], v16 offset:3072
    ds_read_b128 v[56:59], v16 offset:4096
    ds_read_b128 v[60:63], v16 offset:5120
    ds_read_b128 v[64:67], v16 offset:6144
    ds_read_b128 v[68:71], v16 offset:7168
    s_waitcnt lgkmcnt(0)
    v_mul_f32 v40, v40, v24
    v_fma_f32 v128, v128, v23, v40
    v_mul_f32 v41, v41, v24
    v_fma_f32 v129, v129, v23, v41
    v_mul_f32 v42, v42, v24
    v_fma_f32 v130, v130, v23, v42
    v_mul_f32 v43, v43, v24
    v_fma_f32 v131, v131, v23, v43
    buffer_store_dwordx4 v[128:131], v19, s[24:27], s46 offen offset:0
    v_mul_f32 v44, v44, v24
    v_fma_f32 v132, v132, v23, v44
    v_mul_f32 v45, v45, v24
    v_fma_f32 v133, v133, v23, v45
    v_mul_f32 v46, v46, v24
    v_fma_f32 v134, v134, v23, v46
    v_mul_f32 v47, v47, v24
    v_fma_f32 v135, v135, v23, v47
    buffer_store_dwordx4 v[132:135], v19, s[24:27], s46 offen offset:64
    v_mul_f32 v48, v48, v24
    v_fma_f32 v136, v136, v23, v48
    v_mul_f32 v49, v49, v24
    v_fma_f32 v137, v137, v23, v49
    v_mul_f32 v50, v50, v24
    v_fma_f32 v138, v138, v23, v50
    v_mul_f32 v51, v51, v24
    v_fma_f32 v139, v139, v23, v51
    buffer_store_dwordx4 v[136:139], v19, s[24:27], s46 offen offset:128
    v_mul_f32 v52, v52, v24
    v_fma_f32 v140, v140, v23, v52
    v_mul_f32 v53, v53, v24
    v_fma_f32 v141, v141, v23, v53
    v_mul_f32 v54, v54, v24
    v_fma_f32 v142, v142, v23, v54
    v_mul_f32 v55, v55, v24
    v_fma_f32 v143, v143, v23, v55
    buffer_store_dwordx4 v[140:143], v19, s[24:27], s46 offen offset:192
    v_mul_f32 v56, v56, v24
    v_fma_f32 v144, v144, v23, v56
    v_mul_f32 v57, v57, v24
    v_fma_f32 v145, v145, v23, v57
    v_mul_f32 v58, v58, v24
    v_fma_f32 v146, v146, v23, v58
    v_mul_f32 v59, v59, v24
    v_fma_f32 v147, v147, v23, v59
    buffer_store_dwordx4 v[144:147], v19, s[24:27], s46 offen offset:256
    v_mul_f32 v60, v60, v24
    v_fma_f32 v148, v148, v23, v60
    v_mul_f32 v61, v61, v24
    v_fma_f32 v149, v149, v23, v61
    v_mul_f32 v62, v62, v24
    v_fma_f32 v150, v150, v23, v62
    v_mul_f32 v63, v63, v24
    v_fma_f32 v151, v151, v23, v63
    buffer_store_dwordx4 v[148:151], v19, s[24:27], s46 offen offset:320
    v_mul_f32 v64, v64, v24
    v_fma_f32 v152, v152, v23, v64
    v_mul_f32 v65, v65, v24
    v_fma_f32 v153, v153, v23, v65
    v_mul_f32 v66, v66, v24
    v_fma_f32 v154, v154, v23, v66
    v_mul_f32 v67, v67, v24
    v_fma_f32 v155, v155, v23, v67
    buffer_store_dwordx4 v[152:155], v19, s[24:27], s46 offen offset:384
    v_mul_f32 v68, v68, v24
    v_fma_f32 v156, v156, v23, v68
    v_mul_f32 v69, v69, v24
    v_fma_f32 v157, v157, v23, v69
    v_mul_f32 v70, v70, v24
    v_fma_f32 v158, v158, v23, v70
    v_mul_f32 v71, v71, v24
    v_fma_f32 v159, v159, v23, v71
    buffer_store_dwordx4 v[156:159], v19, s[24:27], s46 offen offset:448
    ds_read_b128 v[40:43], v16 offset:8192
    ds_read_b128 v[44:47], v16 offset:9216
    ds_read_b128 v[48:51], v16 offset:10240
    ds_read_b128 v[52:55], v16 offset:11264
    ds_read_b128 v[56:59], v16 offset:12288
    ds_read_b128 v[60:63], v16 offset:13312
    ds_read_b128 v[64:67], v16 offset:14336
    ds_read_b128 v[68:71], v16 offset:15360
    s_waitcnt lgkmcnt(0)
    v_mul_f32 v40, v40, v24
    v_fma_f32 v160, v160, v23, v40
    v_mul_f32 v41, v41, v24
    v_fma_f32 v161, v161, v23, v41
    v_mul_f32 v42, v42, v24
    v_fma_f32 v162, v162, v23, v42
    v_mul_f32 v43, v43, v24
    v_fma_f32 v163, v163, v23, v43
    buffer_store_dwordx4 v[160:163], v19, s[24:27], s46 offen offset:512
    v_mul_f32 v44, v44, v24
    v_fma_f32 v164, v164, v23, v44
    v_mul_f32 v45, v45, v24
    v_fma_f32 v165, v165, v23, v45
    v_mul_f32 v46, v46, v24
    v_fma_f32 v166, v166, v23, v46
    v_mul_f32 v47, v47, v24
    v_fma_f32 v167, v167, v23, v47
    buffer_store_dwordx4 v[164:167], v19, s[24:27], s46 offen offset:576
    v_mul_f32 v48, v48, v24
    v_fma_f32 v168, v168, v23, v48
    v_mul_f32 v49, v49, v24
    v_fma_f32 v169, v169, v23, v49
    v_mul_f32 v50, v50, v24
    v_fma_f32 v170, v170, v23, v50
    v_mul_f32 v51, v51, v24
    v_fma_f32 v171, v171, v23, v51
    buffer_store_dwordx4 v[168:171], v19, s[24:27], s46 offen offset:640
    v_mul_f32 v52, v52, v24
    v_fma_f32 v172, v172, v23, v52
    v_mul_f32 v53, v53, v24
    v_fma_f32 v173, v173, v23, v53
    v_mul_f32 v54, v54, v24
    v_fma_f32 v174, v174, v23, v54
    v_mul_f32 v55, v55, v24
    v_fma_f32 v175, v175, v23, v55
    buffer_store_dwordx4 v[172:175], v19, s[24:27], s46 offen offset:704
    v_mul_f32 v56, v56, v24
    v_fma_f32 v176, v176, v23, v56
    v_mul_f32 v57, v57, v24
    v_fma_f32 v177, v177, v23, v57
    v_mul_f32 v58, v58, v24
    v_fma_f32 v178, v178, v23, v58
    v_mul_f32 v59, v59, v24
    v_fma_f32 v179, v179, v23, v59
    buffer_store_dwordx4 v[176:179], v19, s[24:27], s46 offen offset:768
    v_mul_f32 v60, v60, v24
    v_fma_f32 v180, v180, v23, v60
    v_mul_f32 v61, v61, v24
    v_fma_f32 v181, v181, v23, v61
    v_mul_f32 v62, v62, v24
    v_fma_f32 v182, v182, v23, v62
    v_mul_f32 v63, v63, v24
    v_fma_f32 v183, v183, v23, v63
    buffer_store_dwordx4 v[180:183], v19, s[24:27], s46 offen offset:832
    v_mul_f32 v64, v64, v24
    v_fma_f32 v184, v184, v23, v64
    v_mul_f32 v65, v65, v24
    v_fma_f32 v185, v185, v23, v65
    v_mul_f32 v66, v66, v24
    v_fma_f32 v186, v186, v23, v66
    v_mul_f32 v67, v67, v24
    v_fma_f32 v187, v187, v23, v67
    buffer_store_dwordx4 v[184:187], v19, s[24:27], s46 offen offset:896
    v_mul_f32 v68, v68, v24
    v_fma_f32 v188, v188, v23, v68
    v_mul_f32 v69, v69, v24
    v_fma_f32 v189, v189, v23, v69
    v_mul_f32 v70, v70, v24
    v_fma_f32 v190, v190, v23, v70
    v_mul_f32 v71, v71, v24
    v_fma_f32 v191, v191, v23, v71
    buffer_store_dwordx4 v[188:191], v19, s[24:27], s46 offen offset:960
    ds_read_b128 v[40:43], v16 offset:16384
    ds_read_b128 v[44:47], v16 offset:17408
    ds_read_b128 v[48:51], v16 offset:18432
    ds_read_b128 v[52:55], v16 offset:19456
    ds_read_b128 v[56:59], v16 offset:20480
    ds_read_b128 v[60:63], v16 offset:21504
    ds_read_b128 v[64:67], v16 offset:22528
    ds_read_b128 v[68:71], v16 offset:23552
    s_waitcnt lgkmcnt(0)
    v_mul_f32 v40, v40, v24
    v_fma_f32 v192, v192, v23, v40
    v_mul_f32 v41, v41, v24
    v_fma_f32 v193, v193, v23, v41
    v_mul_f32 v42, v42, v24
    v_fma_f32 v194, v194, v23, v42
    v_mul_f32 v43, v43, v24
    v_fma_f32 v195, v195, v23, v43
    buffer_store_dwordx4 v[192:195], v19, s[24:27], s46 offen offset:1024
    v_mul_f32 v44, v44, v24
    v_fma_f32 v196, v196, v23, v44
    v_mul_f32 v45, v45, v24
    v_fma_f32 v197, v197, v23, v45
    v_mul_f32 v46, v46, v24
    v_fma_f32 v198, v198, v23, v46
    v_mul_f32 v47, v47, v24
    v_fma_f32 v199, v199, v23, v47
    buffer_store_dwordx4 v[196:199], v19, s[24:27], s46 offen offset:1088
    v_mul_f32 v48, v48, v24
    v_fma_f32 v200, v200, v23, v48
    v_mul_f32 v49, v49, v24
    v_fma_f32 v201, v201, v23, v49
    v_mul_f32 v50, v50, v24
    v_fma_f32 v202, v202, v23, v50
    v_mul_f32 v51, v51, v24
    v_fma_f32 v203, v203, v23, v51
    buffer_store_dwordx4 v[200:203], v19, s[24:27], s46 offen offset:1152
    v_mul_f32 v52, v52, v24
    v_fma_f32 v204, v204, v23, v52
    v_mul_f32 v53, v53, v24
    v_fma_f32 v205, v205, v23, v53
    v_mul_f32 v54, v54, v24
    v_fma_f32 v206, v206, v23, v54
    v_mul_f32 v55, v55, v24
    v_fma_f32 v207, v207, v23, v55
    buffer_store_dwordx4 v[204:207], v19, s[24:27], s46 offen offset:1216
    v_mul_f32 v56, v56, v24
    v_fma_f32 v208, v208, v23, v56
    v_mul_f32 v57, v57, v24
    v_fma_f32 v209, v209, v23, v57
    v_mul_f32 v58, v58, v24
    v_fma_f32 v210, v210, v23, v58
    v_mul_f32 v59, v59, v24
    v_fma_f32 v211, v211, v23, v59
    buffer_store_dwordx4 v[208:211], v19, s[24:27], s46 offen offset:1280
    v_mul_f32 v60, v60, v24
    v_fma_f32 v212, v212, v23, v60
    v_mul_f32 v61, v61, v24
    v_fma_f32 v213, v213, v23, v61
    v_mul_f32 v62, v62, v24
    v_fma_f32 v214, v214, v23, v62
    v_mul_f32 v63, v63, v24
    v_fma_f32 v215, v215, v23, v63
    buffer_store_dwordx4 v[212:215], v19, s[24:27], s46 offen offset:1344
    v_mul_f32 v64, v64, v24
    v_fma_f32 v216, v216, v23, v64
    v_mul_f32 v65, v65, v24
    v_fma_f32 v217, v217, v23, v65
    v_mul_f32 v66, v66, v24
    v_fma_f32 v218, v218, v23, v66
    v_mul_f32 v67, v67, v24
    v_fma_f32 v219, v219, v23, v67
    buffer_store_dwordx4 v[216:219], v19, s[24:27], s46 offen offset:1408
    v_mul_f32 v68, v68, v24
    v_fma_f32 v220, v220, v23, v68
    v_mul_f32 v69, v69, v24
    v_fma_f32 v221, v221, v23, v69
    v_mul_f32 v70, v70, v24
    v_fma_f32 v222, v222, v23, v70
    v_mul_f32 v71, v71, v24
    v_fma_f32 v223, v223, v23, v71
    buffer_store_dwordx4 v[220:223], v19, s[24:27], s46 offen offset:1472
    ds_read_b128 v[40:43], v16 offset:24576
    ds_read_b128 v[44:47], v16 offset:25600
    ds_read_b128 v[48:51], v16 offset:26624
    ds_read_b128 v[52:55], v16 offset:27648
    ds_read_b128 v[56:59], v16 offset:28672
    ds_read_b128 v[60:63], v16 offset:29696
    ds_read_b128 v[64:67], v16 offset:30720
    ds_read_b128 v[68:71], v16 offset:31744
    s_waitcnt lgkmcnt(0)
    v_mul_f32 v40, v40, v24
    v_fma_f32 v224, v224, v23, v40
    v_mul_f32 v41, v41, v24
    v_fma_f32 v225, v225, v23, v41
    v_mul_f32 v42, v42, v24
    v_fma_f32 v226, v226, v23, v42
    v_mul_f32 v43, v43, v24
    v_fma_f32 v227, v227, v23, v43
    buffer_store_dwordx4 v[224:227], v19, s[24:27], s46 offen offset:1536
    v_mul_f32 v44, v44, v24
    v_fma_f32 v228, v228, v23, v44
    v_mul_f32 v45, v45, v24
    v_fma_f32 v229, v229, v23, v45
    v_mul_f32 v46, v46, v24
    v_fma_f32 v230, v230, v23, v46
    v_mul_f32 v47, v47, v24
    v_fma_f32 v231, v231, v23, v47
    buffer_store_dwordx4 v[228:231], v19, s[24:27], s46 offen offset:1600
    v_mul_f32 v48, v48, v24
    v_fma_f32 v232, v232, v23, v48
    v_mul_f32 v49, v49, v24
    v_fma_f32 v233, v233, v23, v49
    v_mul_f32 v50, v50, v24
    v_fma_f32 v234, v234, v23, v50
    v_mul_f32 v51, v51, v24
    v_fma_f32 v235, v235, v23, v51
    buffer_store_dwordx4 v[232:235], v19, s[24:27], s46 offen offset:1664
    v_mul_f32 v52, v52, v24
    v_fma_f32 v236, v236, v23, v52
    v_mul_f32 v53, v53, v24
    v_fma_f32 v237, v237, v23, v53
    v_mul_f32 v54, v54, v24
    v_fma_f32 v238, v238, v23, v54
    v_mul_f32 v55, v55, v24
    v_fma_f32 v239, v239, v23, v55
    buffer_store_dwordx4 v[236:239], v19, s[24:27], s46 offen offset:1728
    v_mul_f32 v56, v56, v24
    v_fma_f32 v240, v240, v23, v56
    v_mul_f32 v57, v57, v24
    v_fma_f32 v241, v241, v23, v57
    v_mul_f32 v58, v58, v24
    v_fma_f32 v242, v242, v23, v58
    v_mul_f32 v59, v59, v24
    v_fma_f32 v243, v243, v23, v59
    buffer_store_dwordx4 v[240:243], v19, s[24:27], s46 offen offset:1792
    v_mul_f32 v60, v60, v24
    v_fma_f32 v244, v244, v23, v60
    v_mul_f32 v61, v61, v24
    v_fma_f32 v245, v245, v23, v61
    v_mul_f32 v62, v62, v24
    v_fma_f32 v246, v246, v23, v62
    v_mul_f32 v63, v63, v24
    v_fma_f32 v247, v247, v23, v63
    buffer_store_dwordx4 v[244:247], v19, s[24:27], s46 offen offset:1856
    v_mul_f32 v64, v64, v24
    v_fma_f32 v248, v248, v23, v64
    v_mul_f32 v65, v65, v24
    v_fma_f32 v249, v249, v23, v65
    v_mul_f32 v66, v66, v24
    v_fma_f32 v250, v250, v23, v66
    v_mul_f32 v67, v67, v24
    v_fma_f32 v251, v251, v23, v67
    buffer_store_dwordx4 v[248:251], v19, s[24:27], s46 offen offset:1920
    v_mul_f32 v68, v68, v24
    v_fma_f32 v252, v252, v23, v68
    v_mul_f32 v69, v69, v24
    v_fma_f32 v253, v253, v23, v69
    v_mul_f32 v70, v70, v24
    v_fma_f32 v254, v254, v23, v70
    v_mul_f32 v71, v71, v24
    v_fma_f32 v255, v255, v23, v71
    buffer_store_dwordx4 v[252:255], v19, s[24:27], s46 offen offset:1984
    v_lshlrev_b32 v19, 8, v3
    s_lshl_b32 s46, s34, 13
    s_lshl_b32 s47, s42, 12
    s_add_u32 s46, s46, s47
    s_lshl_b32 s47, s35, 3
    s_add_u32 s46, s46, s47
    s_add_u32 s46, s46, 0x900000
    v_cmp_gt_u32 vcc, 16, v1
    s_and_saveexec_b64 s[40:41], vcc
    buffer_store_dwordx2 v[10:11], v19, s[24:27], s46 offen
    s_endpgm
Lk2_end:
    s_endpgm
.p2align 8
.type k3_kernel,@function
k3_kernel:
    s_cmp_ge_u32 s2, 256
    s_cbranch_scc1 Lk3_end
    s_lshr_b32 s28, s2, 7
    s_bfe_u32 s3, s2, 0x50002
    s_and_b32 s34, s2, 3
    s_and_b32 s35, s2, 127
    s_load_dwordx2 s[10:11], s[0:1], 104
    v_and_b32 v1, 63, v0
    v_lshrrev_b32 v2, 4, v1
    v_and_b32 v3, 15, v1
    v_lshrrev_b32 v4, 6, v0
    s_nop 0
    v_readfirstlane_b32 s29, v4
    s_mov_b32 s30, 0x05040100
    s_mov_b32 s31, 0x07060302
    s_cmp_eq_u32 s28, 1
    s_cbranch_scc1 Lk3_b
    s_load_dwordx2 s[4:5], s[0:1], 32
    s_waitcnt lgkmcnt(0)
    s_mov_b32 s12, s4
    s_mov_b32 s13, s5
    s_mov_b32 s14, 0x400000
    s_mov_b32 s15, 0x00020000
    s_mov_b32 s24, s10
    s_mov_b32 s25, s11
    s_mov_b32 s26, 0x10000000
    s_mov_b32 s27, 0x00020000
    v_lshlrev_b32 v5, 13, v2
    v_lshl_add_u32 v5, v3, 4, v5
    s_lshl_b32 s36, s3, 17
    s_lshl_b32 s37, s29, 15
    s_add_u32 s36, s36, s37
    s_lshl_b32 s37, s34, 8
    s_add_u32 s36, s36, s37
    buffer_load_dwordx4 v[32:35], v5, s[12:15], s36 offen offset:0 nt
    buffer_load_dwordx4 v[36:39], v5, s[12:15], s36 offen offset:1024 nt
    buffer_load_dwordx4 v[40:43], v5, s[12:15], s36 offen offset:2048 nt
    buffer_load_dwordx4 v[44:47], v5, s[12:15], s36 offen offset:3072 nt
    s_add_u32 s36, s36, 4096
    buffer_load_dwordx4 v[48:51], v5, s[12:15], s36 offen offset:0 nt
    buffer_load_dwordx4 v[52:55], v5, s[12:15], s36 offen offset:1024 nt
    buffer_load_dwordx4 v[56:59], v5, s[12:15], s36 offen offset:2048 nt
    buffer_load_dwordx4 v[60:63], v5, s[12:15], s36 offen offset:3072 nt
    v_mov_b32 v8, 0
    v_mov_b32 v9, 0
    v_mov_b32 v10, 0
    v_mov_b32 v11, 0
    v_lshlrev_b32 v6, 16, v3
    v_lshl_add_u32 v6, v2, 5, v6
    s_lshl_b32 s36, s3, 11
    s_lshl_b32 s37, s29, 7
    s_add_u32 s36, s36, s37
    s_add_u32 s36, s36, 0x40000
    v_lshlrev_b32 v7, 10, v3
    s_lshl_b32 s37, s3, 5
    s_add_u32 s37, s37, 0x80000
    v_cmp_gt_u32 vcc, 4, v3
    s_and_saveexec_b64 s[40:41], vcc
    s_cbranch_execz Lk3a_skip
    buffer_load_dwordx4 v[64:67], v6, s[24:27], s36 offen offset:0
    buffer_load_dwordx4 v[68:71], v6, s[24:27], s36 offen offset:16
    buffer_load_dwordx4 v[72:75], v6, s[24:27], s36 offen offset:512
    buffer_load_dwordx4 v[76:79], v6, s[24:27], s36 offen offset:528
    buffer_load_dwordx4 v[80:83], v6, s[24:27], s36 offen offset:1024
    buffer_load_dwordx4 v[84:87], v6, s[24:27], s36 offen offset:1040
    buffer_load_dwordx4 v[88:91], v6, s[24:27], s36 offen offset:1536
    buffer_load_dwordx4 v[92:95], v6, s[24:27], s36 offen offset:1552
    buffer_load_dwordx4 v[96:99], v7, s[24:27], s37 offen
    buffer_load_dwordx4 v[100:103], v7, s[24:27], s37 offen offset:16
    s_waitcnt vmcnt(0)
    v_max3_f32 v104, v96, v98, v100
    v_max_f32 v104, v104, v102
    v_sub_f32 v96, v96, v104
    v_sub_f32 v98, v98, v104
    v_sub_f32 v100, v100, v104
    v_sub_f32 v102, v102, v104
    v_exp_f32 v96, v96
    v_exp_f32 v98, v98
    v_exp_f32 v100, v100
    v_exp_f32 v102, v102
    s_nop 0
    v_mul_f32 v105, v96, v97
    v_fma_f32 v105, v98, v99, v105
    v_fma_f32 v105, v100, v101, v105
    v_fma_f32 v105, v102, v103, v105
    v_rcp_f32 v105, v105
    s_nop 0
    v_mul_f32 v96, v96, v105
    v_mul_f32 v98, v98, v105
    v_mul_f32 v100, v100, v105
    v_mul_f32 v102, v102, v105
    v_mul_f32 v64, v64, v96
    v_fma_f32 v64, v72, v98, v64
    v_fma_f32 v64, v80, v100, v64
    v_fma_f32 v64, v88, v102, v64
    v_mul_f32 v65, v65, v96
    v_fma_f32 v65, v73, v98, v65
    v_fma_f32 v65, v81, v100, v65
    v_fma_f32 v65, v89, v102, v65
    v_mul_f32 v66, v66, v96
    v_fma_f32 v66, v74, v98, v66
    v_fma_f32 v66, v82, v100, v66
    v_fma_f32 v66, v90, v102, v66
    v_mul_f32 v67, v67, v96
    v_fma_f32 v67, v75, v98, v67
    v_fma_f32 v67, v83, v100, v67
    v_fma_f32 v67, v91, v102, v67
    v_mul_f32 v68, v68, v96
    v_fma_f32 v68, v76, v98, v68
    v_fma_f32 v68, v84, v100, v68
    v_fma_f32 v68, v92, v102, v68
    v_mul_f32 v69, v69, v96
    v_fma_f32 v69, v77, v98, v69
    v_fma_f32 v69, v85, v100, v69
    v_fma_f32 v69, v93, v102, v69
    v_mul_f32 v70, v70, v96
    v_fma_f32 v70, v78, v98, v70
    v_fma_f32 v70, v86, v100, v70
    v_fma_f32 v70, v94, v102, v70
    v_mul_f32 v71, v71, v96
    v_fma_f32 v71, v79, v98, v71
    v_fma_f32 v71, v87, v100, v71
    v_fma_f32 v71, v95, v102, v71
    v_cvt_pk_bf16_f32 v8, v64, v65
    v_cvt_pk_bf16_f32 v9, v66, v67
    v_cvt_pk_bf16_f32 v10, v68, v69
    v_cvt_pk_bf16_f32 v11, v70, v71
Lk3a_skip:
    s_mov_b64 exec, s[40:41]
    s_waitcnt vmcnt(0)
    v_perm_b32 v112, v36, v32, s30
    v_perm_b32 v113, v44, v40, s30
    v_perm_b32 v114, v52, v48, s30
    v_perm_b32 v115, v60, v56, s30
    s_nop 1
    v_mfma_f32_16x16x32_bf16 v[64:67], v[112:115], v[8:11], 0
    v_perm_b32 v116, v36, v32, s31
    v_perm_b32 v117, v44, v40, s31
    v_perm_b32 v118, v52, v48, s31
    v_perm_b32 v119, v60, v56, s31
    s_nop 1
    v_mfma_f32_16x16x32_bf16 v[68:71], v[116:119], v[8:11], 0
    v_perm_b32 v112, v37, v33, s30
    v_perm_b32 v113, v45, v41, s30
    v_perm_b32 v114, v53, v49, s30
    v_perm_b32 v115, v61, v57, s30
    s_nop 1
    v_mfma_f32_16x16x32_bf16 v[72:75], v[112:115], v[8:11], 0
    v_perm_b32 v116, v37, v33, s31
    v_perm_b32 v117, v45, v41, s31
    v_perm_b32 v118, v53, v49, s31
    v_perm_b32 v119, v61, v57, s31
    s_nop 1
    v_mfma_f32_16x16x32_bf16 v[76:79], v[116:119], v[8:11], 0
    v_perm_b32 v112, v38, v34, s30
    v_perm_b32 v113, v46, v42, s30
    v_perm_b32 v114, v54, v50, s30
    v_perm_b32 v115, v62, v58, s30
    s_nop 1
    v_mfma_f32_16x16x32_bf16 v[80:83], v[112:115], v[8:11], 0
    v_perm_b32 v116, v38, v34, s31
    v_perm_b32 v117, v46, v42, s31
    v_perm_b32 v118, v54, v50, s31
    v_perm_b32 v119, v62, v58, s31
    s_nop 1
    v_mfma_f32_16x16x32_bf16 v[84:87], v[116:119], v[8:11], 0
    v_perm_b32 v112, v39, v35, s30
    v_perm_b32 v113, v47, v43, s30
    v_perm_b32 v114, v55, v51, s30
    v_perm_b32 v115, v63, v59, s30
    s_nop 1
    v_mfma_f32_16x16x32_bf16 v[88:91], v[112:115], v[8:11], 0
    v_perm_b32 v116, v39, v35, s31
    v_perm_b32 v117, v47, v43, s31
    v_perm_b32 v118, v55, v51, s31
    v_perm_b32 v119, v63, v59, s31
    s_nop 1
    v_mfma_f32_16x16x32_bf16 v[92:95], v[116:119], v[8:11], 0
    s_nop 7
    s_nop 3
    v_lshlrev_b32 v15, 9, v3
    v_lshl_add_u32 v15, v2, 7, v15
    s_lshl_b32 s38, s29, 11
    v_add_u32 v15, s38, v15
    v_cmp_gt_u32 vcc, 4, v3
    s_and_saveexec_b64 s[40:41], vcc
    ds_write_b128 v15, v[64:67] offset:0
    ds_write_b128 v15, v[68:71] offset:16
    ds_write_b128 v15, v[72:75] offset:32
    ds_write_b128 v15, v[76:79] offset:48
    ds_write_b128 v15, v[80:83] offset:64
    ds_write_b128 v15, v[84:87] offset:80
    ds_write_b128 v15, v[88:91] offset:96
    ds_write_b128 v15, v[92:95] offset:112
    s_mov_b64 exec, s[40:41]
    s_waitcnt lgkmcnt(0)
    s_barrier
    v_lshlrev_b32 v16, 2, v0
    ds_read_b32 v20, v16 offset:0
    ds_read_b32 v21, v16 offset:2048
    ds_read_b32 v22, v16 offset:4096
    ds_read_b32 v23, v16 offset:6144
    ds_read_b32 v24, v16 offset:1024
    ds_read_b32 v25, v16 offset:3072
    ds_read_b32 v26, v16 offset:5120
    ds_read_b32 v27, v16 offset:7168
    s_waitcnt lgkmcnt(0)
    v_add_f32 v20, v20, v21
    v_add_f32 v22, v22, v23
    v_add_f32 v20, v20, v22
    v_add_f32 v24, v24, v25
    v_add_f32 v26, v26, v27
    v_add_f32 v24, v24, v26
    s_lshl_b32 s38, s35, 11
    s_add_u32 s38, s38, 0xa00000
    buffer_store_dword v20, v16, s[24:27], s38 offen
    buffer_store_dword v24, v16, s[24:27], s38 offen offset:1024
    s_endpgm
Lk3_b:
    s_load_dwordx2 s[4:5], s[0:1], 72
    s_load_dwordx2 s[6:7], s[0:1], 80
    s_waitcnt lgkmcnt(0)
    s_mov_b32 s12, s4
    s_mov_b32 s13, s5
    s_mov_b32 s14, 0x400000
    s_mov_b32 s15, 0x00020000
    s_mov_b32 s16, s6
    s_mov_b32 s17, s7
    s_mov_b32 s18, 0x400000
    s_mov_b32 s19, 0x00020000
    s_mov_b32 s24, s10
    s_mov_b32 s25, s11
    s_mov_b32 s26, 0x10000000
    s_mov_b32 s27, 0x00020000
    v_and_b32 v5, 31, v1
    v_lshlrev_b32 v5, 3, v5
    s_lshl_b32 s36, s29, 13
    s_lshl_b32 s37, s3, 8
    s_add_u32 s36, s36, s37
    s_add_u32 s36, s36, 0x900000
    buffer_load_dwordx2 v[8:9], v5, s[24:27], s36 offen
    v_lshlrev_b32 v6, 3, v1
    s_lshl_b32 s36, s29, 21
    s_lshl_b32 s37, s3, 11
    s_add_u32 s36, s36, s37
    s_lshl_b32 s37, s34, 9
    s_add_u32 s36, s36, s37
    s_add_u32 s36, s36, 0x100000
    buffer_load_dwordx2 v[32:33], v6, s[24:27], s36 offen
    s_add_u32 s36, s36, 65536
    buffer_load_dwordx2 v[34:35], v6, s[24:27], s36 offen
    s_add_u32 s36, s36, 65536
    buffer_load_dwordx2 v[36:37], v6, s[24:27], s36 offen
    s_add_u32 s36, s36, 65536
    buffer_load_dwordx2 v[38:39], v6, s[24:27], s36 offen
    s_add_u32 s36, s36, 65536
    buffer_load_dwordx2 v[40:41], v6, s[24:27], s36 offen
    s_add_u32 s36, s36, 65536
    buffer_load_dwordx2 v[42:43], v6, s[24:27], s36 offen
    s_add_u32 s36, s36, 65536
    buffer_load_dwordx2 v[44:45], v6, s[24:27], s36 offen
    s_add_u32 s36, s36, 65536
    buffer_load_dwordx2 v[46:47], v6, s[24:27], s36 offen
    s_add_u32 s36, s36, 65536
    buffer_load_dwordx2 v[48:49], v6, s[24:27], s36 offen
    s_add_u32 s36, s36, 65536
    buffer_load_dwordx2 v[50:51], v6, s[24:27], s36 offen
    s_add_u32 s36, s36, 65536
    buffer_load_dwordx2 v[52:53], v6, s[24:27], s36 offen
    s_add_u32 s36, s36, 65536
    buffer_load_dwordx2 v[54:55], v6, s[24:27], s36 offen
    s_add_u32 s36, s36, 65536
    buffer_load_dwordx2 v[56:57], v6, s[24:27], s36 offen
    s_add_u32 s36, s36, 65536
    buffer_load_dwordx2 v[58:59], v6, s[24:27], s36 offen
    s_add_u32 s36, s36, 65536
    buffer_load_dwordx2 v[60:61], v6, s[24:27], s36 offen
    s_add_u32 s36, s36, 65536
    buffer_load_dwordx2 v[62:63], v6, s[24:27], s36 offen
    s_add_u32 s36, s36, 65536
    buffer_load_dwordx2 v[64:65], v6, s[24:27], s36 offen
    s_add_u32 s36, s36, 65536
    buffer_load_dwordx2 v[66:67], v6, s[24:27], s36 offen
    s_add_u32 s36, s36, 65536
    buffer_load_dwordx2 v[68:69], v6, s[24:27], s36 offen
    s_add_u32 s36, s36, 65536
    buffer_load_dwordx2 v[70:71], v6, s[24:27], s36 offen
    s_add_u32 s36, s36, 65536
    buffer_load_dwordx2 v[72:73], v6, s[24:27], s36 offen
    s_add_u32 s36, s36, 65536
    buffer_load_dwordx2 v[74:75], v6, s[24:27], s36 offen
    s_add_u32 s36, s36, 65536
    buffer_load_dwordx2 v[76:77], v6, s[24:27], s36 offen
    s_add_u32 s36, s36, 65536
    buffer_load_dwordx2 v[78:79], v6, s[24:27], s36 offen
    s_add_u32 s36, s36, 65536
    buffer_load_dwordx2 v[80:81], v6, s[24:27], s36 offen
    s_add_u32 s36, s36, 65536
    buffer_load_dwordx2 v[82:83], v6, s[24:27], s36 offen
    s_add_u32 s36, s36, 65536
    buffer_load_dwordx2 v[84:85], v6, s[24:27], s36 offen
    s_add_u32 s36, s36, 65536
    buffer_load_dwordx2 v[86:87], v6, s[24:27], s36 offen
    s_add_u32 s36, s36, 65536
    buffer_load_dwordx2 v[88:89], v6, s[24:27], s36 offen
    s_add_u32 s36, s36, 65536
    buffer_load_dwordx2 v[90:91], v6, s[24:27], s36 offen
    s_add_u32 s36, s36, 65536
    buffer_load_dwordx2 v[92:93], v6, s[24:27], s36 offen
    s_add_u32 s36, s36, 65536
    buffer_load_dwordx2 v[94:95], v6, s[24:27], s36 offen
    v_lshlrev_b32 v5, 16, v2
    v_lshl_add_u32 v5, v3, 4, v5
    s_lshl_b32 s36, s34, 20
    s_lshl_b32 s37, s29, 18
    s_add_u32 s36, s36, s37
    s_lshl_b32 s37, s3, 8
    s_add_u32 s36, s36, s37
    buffer_load_dwordx4 v[96:99], v5, s[12:15], s36 offen nt
    s_add_u32 s36, s36, 8192
    buffer_load_dwordx4 v[100:103], v5, s[12:15], s36 offen nt
    s_add_u32 s36, s36, 8192
    buffer_load_dwordx4 v[104:107], v5, s[12:15], s36 offen nt
    s_add_u32 s36, s36, 8192
    buffer_load_dwordx4 v[108:111], v5, s[12:15], s36 offen nt
    s_add_u32 s36, s36, 8192
    buffer_load_dwordx4 v[112:115], v5, s[12:15], s36 offen nt
    s_add_u32 s36, s36, 8192
    buffer_load_dwordx4 v[116:119], v5, s[12:15], s36 offen nt
    s_add_u32 s36, s36, 8192
    buffer_load_dwordx4 v[120:123], v5, s[12:15], s36 offen nt
    s_add_u32 s36, s36, 8192
    buffer_load_dwordx4 v[124:127], v5, s[12:15], s36 offen nt
    v_lshlrev_b32 v5, 13, v2
    v_lshl_add_u32 v5, v3, 4, v5
    s_lshl_b32 s36, s3, 17
    s_lshl_b32 s37, s29, 8
    s_add_u32 s36, s36, s37
    buffer_load_dwordx4 v[128:131], v5, s[16:19], s36 offen offset:0
    buffer_load_dwordx4 v[132:135], v5, s[16:19], s36 offen offset:1024
    buffer_load_dwordx4 v[136:139], v5, s[16:19], s36 offen offset:2048
    buffer_load_dwordx4 v[140:143], v5, s[16:19], s36 offen offset:3072
    s_add_u32 s36, s36, 4096
    buffer_load_dwordx4 v[144:147], v5, s[16:19], s36 offen offset:0
    buffer_load_dwordx4 v[148:151], v5, s[16:19], s36 offen offset:1024
    buffer_load_dwordx4 v[152:155], v5, s[16:19], s36 offen offset:2048
    buffer_load_dwordx4 v[156:159], v5, s[16:19], s36 offen offset:3072
    s_add_u32 s36, s36, 28672
    buffer_load_dwordx4 v[160:163], v5, s[16:19], s36 offen offset:0
    buffer_load_dwordx4 v[164:167], v5, s[16:19], s36 offen offset:1024
    buffer_load_dwordx4 v[168:171], v5, s[16:19], s36 offen offset:2048
    buffer_load_dwordx4 v[172:175], v5, s[16:19], s36 offen offset:3072
    s_add_u32 s36, s36, 4096
    buffer_load_dwordx4 v[176:179], v5, s[16:19], s36 offen offset:0
    buffer_load_dwordx4 v[180:183], v5, s[16:19], s36 offen offset:1024
    buffer_load_dwordx4 v[184:187], v5, s[16:19], s36 offen offset:2048
    buffer_load_dwordx4 v[188:191], v5, s[16:19], s36 offen offset:3072
    s_add_u32 s36, s36, 28672
    buffer_load_dwordx4 v[192:195], v5, s[16:19], s36 offen offset:0
    buffer_load_dwordx4 v[196:199], v5, s[16:19], s36 offen offset:1024
    buffer_load_dwordx4 v[200:203], v5, s[16:19], s36 offen offset:2048
    buffer_load_dwordx4 v[204:207], v5, s[16:19], s36 offen offset:3072
    s_add_u32 s36, s36, 4096
    buffer_load_dwordx4 v[208:211], v5, s[16:19], s36 offen offset:0
    buffer_load_dwordx4 v[212:215], v5, s[16:19], s36 offen offset:1024
    buffer_load_dwordx4 v[216:219], v5, s[16:19], s36 offen offset:2048
    buffer_load_dwordx4 v[220:223], v5, s[16:19], s36 offen offset:3072
    s_add_u32 s36, s36, 28672
    buffer_load_dwordx4 v[224:227], v5, s[16:19], s36 offen offset:0
    buffer_load_dwordx4 v[228:231], v5, s[16:19], s36 offen offset:1024
    buffer_load_dwordx4 v[232:235], v5, s[16:19], s36 offen offset:2048
    buffer_load_dwordx4 v[236:239], v5, s[16:19], s36 offen offset:3072
    s_add_u32 s36, s36, 4096
    buffer_load_dwordx4 v[240:243], v5, s[16:19], s36 offen offset:0
    buffer_load_dwordx4 v[244:247], v5, s[16:19], s36 offen offset:1024
    buffer_load_dwordx4 v[248:251], v5, s[16:19], s36 offen offset:2048
    buffer_load_dwordx4 v[252:255], v5, s[16:19], s36 offen offset:3072
    s_waitcnt vmcnt(63)
    v_mov_b32 v10, v8
    s_nop 1
    v_mov_b32_dpp v11, v10 row_ror:1 row_mask:0xf bank_mask:0xf
    v_max_f32 v10, v10, v11
    s_nop 1
    v_mov_b32_dpp v11, v10 row_ror:2 row_mask:0xf bank_mask:0xf
    v_max_f32 v10, v10, v11
    s_nop 1
    v_mov_b32_dpp v11, v10 row_ror:4 row_mask:0xf bank_mask:0xf
    v_max_f32 v10, v10, v11
    s_nop 1
    v_mov_b32_dpp v11, v10 row_ror:8 row_mask:0xf bank_mask:0xf
    v_max_f32 v10, v10, v11
    v_mov_b32 v11, v10
    s_nop 1
    v_permlane16_swap_b32 v10, v11
    s_nop 1
    v_max_f32 v10, v10, v11
    v_sub_f32 v10, v8, v10
    v_exp_f32 v10, v10
    s_nop 0
    v_mul_f32 v12, v10, v9
    s_nop 1
    v_mov_b32_dpp v11, v12 row_ror:1 row_mask:0xf bank_mask:0xf
    v_add_f32 v12, v12, v11
    s_nop 1
    v_mov_b32_dpp v11, v12 row_ror:2 row_mask:0xf bank_mask:0xf
    v_add_f32 v12, v12, v11
    s_nop 1
    v_mov_b32_dpp v11, v12 row_ror:4 row_mask:0xf bank_mask:0xf
    v_add_f32 v12, v12, v11
    s_nop 1
    v_mov_b32_dpp v11, v12 row_ror:8 row_mask:0xf bank_mask:0xf
    v_add_f32 v12, v12, v11
    v_mov_b32 v11, v12
    s_nop 1
    v_permlane16_swap_b32 v12, v11
    s_nop 1
    v_add_f32 v12, v12, v11
    v_rcp_f32 v12, v12
    s_nop 0
    v_mul_f32 v10, v10, v12
    s_nop 1
    v_readlane_b32 s64, v10, 0
    v_readlane_b32 s65, v10, 1
    v_readlane_b32 s66, v10, 2
    v_readlane_b32 s67, v10, 3
    v_readlane_b32 s68, v10, 4
    v_readlane_b32 s69, v10, 5
    v_readlane_b32 s70, v10, 6
    v_readlane_b32 s71, v10, 7
    v_readlane_b32 s72, v10, 8
    v_readlane_b32 s73, v10, 9
    v_readlane_b32 s74, v10, 10
    v_readlane_b32 s75, v10, 11
    v_readlane_b32 s76, v10, 12
    v_readlane_b32 s77, v10, 13
    v_readlane_b32 s78, v10, 14
    v_readlane_b32 s79, v10, 15
    v_readlane_b32 s80, v10, 16
    v_readlane_b32 s81, v10, 17
    v_readlane_b32 s82, v10, 18
    v_readlane_b32 s83, v10, 19
    v_readlane_b32 s84, v10, 20
    v_readlane_b32 s85, v10, 21
    v_readlane_b32 s86, v10, 22
    v_readlane_b32 s87, v10, 23
    v_readlane_b32 s88, v10, 24
    v_readlane_b32 s89, v10, 25
    v_readlane_b32 s90, v10, 26
    v_readlane_b32 s91, v10, 27
    v_readlane_b32 s92, v10, 28
    v_readlane_b32 s93, v10, 29
    v_readlane_b32 s94, v10, 30
    v_readlane_b32 s95, v10, 31
    s_nop 1
    s_waitcnt vmcnt(40)
    v_mul_f32 v13, s64, v32
    v_mul_f32 v14, s64, v33
    v_fma_f32 v13, v34, s65, v13
    v_fma_f32 v14, v35, s65, v14
    v_fma_f32 v13, v36, s66, v13
    v_fma_f32 v14, v37, s66, v14
    v_fma_f32 v13, v38, s67, v13
    v_fma_f32 v14, v39, s67, v14
    v_fma_f32 v13, v40, s68, v13
    v_fma_f32 v14, v41, s68, v14
    v_fma_f32 v13, v42, s69, v13
    v_fma_f32 v14, v43, s69, v14
    v_fma_f32 v13, v44, s70, v13
    v_fma_f32 v14, v45, s70, v14
    v_fma_f32 v13, v46, s71, v13
    v_fma_f32 v14, v47, s71, v14
    v_fma_f32 v13, v48, s72, v13
    v_fma_f32 v14, v49, s72, v14
    v_fma_f32 v13, v50, s73, v13
    v_fma_f32 v14, v51, s73, v14
    v_fma_f32 v13, v52, s74, v13
    v_fma_f32 v14, v53, s74, v14
    v_fma_f32 v13, v54, s75, v13
    v_fma_f32 v14, v55, s75, v14
    v_fma_f32 v13, v56, s76, v13
    v_fma_f32 v14, v57, s76, v14
    v_fma_f32 v13, v58, s77, v13
    v_fma_f32 v14, v59, s77, v14
    v_fma_f32 v13, v60, s78, v13
    v_fma_f32 v14, v61, s78, v14
    v_fma_f32 v13, v62, s79, v13
    v_fma_f32 v14, v63, s79, v14
    v_fma_f32 v13, v64, s80, v13
    v_fma_f32 v14, v65, s80, v14
    v_fma_f32 v13, v66, s81, v13
    v_fma_f32 v14, v67, s81, v14
    v_fma_f32 v13, v68, s82, v13
    v_fma_f32 v14, v69, s82, v14
    v_fma_f32 v13, v70, s83, v13
    v_fma_f32 v14, v71, s83, v14
    v_fma_f32 v13, v72, s84, v13
    v_fma_f32 v14, v73, s84, v14
    v_fma_f32 v13, v74, s85, v13
    v_fma_f32 v14, v75, s85, v14
    v_fma_f32 v13, v76, s86, v13
    v_fma_f32 v14, v77, s86, v14
    v_fma_f32 v13, v78, s87, v13
    v_fma_f32 v14, v79, s87, v14
    v_fma_f32 v13, v80, s88, v13
    v_fma_f32 v14, v81, s88, v14
    v_fma_f32 v13, v82, s89, v13
    v_fma_f32 v14, v83, s89, v14
    v_fma_f32 v13, v84, s90, v13
    v_fma_f32 v14, v85, s90, v14
    v_fma_f32 v13, v86, s91, v13
    v_fma_f32 v14, v87, s91, v14
    v_fma_f32 v13, v88, s92, v13
    v_fma_f32 v14, v89, s92, v14
    v_fma_f32 v13, v90, s93, v13
    v_fma_f32 v14, v91, s93, v14
    v_fma_f32 v13, v92, s94, v13
    v_fma_f32 v14, v93, s94, v14
    v_fma_f32 v13, v94, s95, v13
    v_fma_f32 v14, v95, s95, v14
    v_cvt_pk_bf16_f32 v13, v13, v14
    s_lshl_b32 s38, s29, 8
    v_lshlrev_b32 v15, 2, v1
    v_add_u32 v15, s38, v15
    ds_write_b32 v15, v13
    s_waitcnt lgkmcnt(0)
    s_barrier
    v_mov_b32 v8, 0
    v_mov_b32 v9, 0
    v_mov_b32 v10, 0
    v_mov_b32 v11, 0
    v_lshlrev_b32 v15, 8, v3
    v_lshl_add_u32 v15, v2, 4, v15
    s_lshl_b32 s38, s29, 6
    v_add_u32 v17, s38, v15
    v_cmp_gt_u32 vcc, 4, v3
    s_and_saveexec_b64 s[40:41], vcc
    ds_read_b128 v[8:11], v17
    s_mov_b64 exec, s[40:41]
    s_waitcnt lgkmcnt(0) vmcnt(32)
    v_perm_b32 v24, v100, v96, s30
    v_perm_b32 v25, v108, v104, s30
    v_perm_b32 v26, v116, v112, s30
    v_perm_b32 v27, v124, v120, s30
    s_nop 1
    v_mfma_f32_16x16x32_bf16 v[32:35], v[24:27], v[8:11], 0
    v_perm_b32 v28, v100, v96, s31
    v_perm_b32 v29, v108, v104, s31
    v_perm_b32 v30, v116, v112, s31
    v_perm_b32 v31, v124, v120, s31
    s_nop 1
    v_mfma_f32_16x16x32_bf16 v[36:39], v[28:31], v[8:11], 0
    v_perm_b32 v24, v101, v97, s30
    v_perm_b32 v25, v109, v105, s30
    v_perm_b32 v26, v117, v113, s30
    v_perm_b32 v27, v125, v121, s30
    s_nop 1
    v_mfma_f32_16x16x32_bf16 v[40:43], v[24:27], v[8:11], 0
    v_perm_b32 v28, v101, v97, s31
    v_perm_b32 v29, v109, v105, s31
    v_perm_b32 v30, v117, v113, s31
    v_perm_b32 v31, v125, v121, s31
    s_nop 1
    v_mfma_f32_16x16x32_bf16 v[44:47], v[28:31], v[8:11], 0
    v_perm_b32 v24, v102, v98, s30
    v_perm_b32 v25, v110, v106, s30
    v_perm_b32 v26, v118, v114, s30
    v_perm_b32 v27, v126, v122, s30
    s_nop 1
    v_mfma_f32_16x16x32_bf16 v[48:51], v[24:27], v[8:11], 0
    v_perm_b32 v28, v102, v98, s31
    v_perm_b32 v29, v110, v106, s31
    v_perm_b32 v30, v118, v114, s31
    v_perm_b32 v31, v126, v122, s31
    s_nop 1
    v_mfma_f32_16x16x32_bf16 v[52:55], v[28:31], v[8:11], 0
    v_perm_b32 v24, v103, v99, s30
    v_perm_b32 v25, v111, v107, s30
    v_perm_b32 v26, v119, v115, s30
    v_perm_b32 v27, v127, v123, s30
    s_nop 1
    v_mfma_f32_16x16x32_bf16 v[56:59], v[24:27], v[8:11], 0
    v_perm_b32 v28, v103, v99, s31
    v_perm_b32 v29, v111, v107, s31
    v_perm_b32 v30, v119, v115, s31
    v_perm_b32 v31, v127, v123, s31
    s_nop 1
    v_mfma_f32_16x16x32_bf16 v[60:63], v[28:31], v[8:11], 0
    s_nop 7
    s_nop 3
    v_lshlrev_b32 v15, 9, v3
    v_lshl_add_u32 v15, v2, 7, v15
    s_lshl_b32 s38, s29, 11
    v_add_u32 v15, s38, v15
    v_cmp_gt_u32 vcc, 4, v3
    s_and_saveexec_b64 s[40:41], vcc
    ds_write_b128 v15, v[32:35] offset:1024
    ds_write_b128 v15, v[36:39] offset:1040
    ds_write_b128 v15, v[40:43] offset:1056
    ds_write_b128 v15, v[44:47] offset:1072
    ds_write_b128 v15, v[48:51] offset:1088
    ds_write_b128 v15, v[52:55] offset:1104
    ds_write_b128 v15, v[56:59] offset:1120
    ds_write_b128 v15, v[60:63] offset:1136
    s_mov_b64 exec, s[40:41]
    s_waitcnt lgkmcnt(0)
    s_barrier
    v_lshlrev_b32 v16, 2, v0
    ds_read_b32 v20, v16 offset:1024
    ds_read_b32 v21, v16 offset:3072
    ds_read_b32 v22, v16 offset:5120
    ds_read_b32 v23, v16 offset:7168
    ds_read_b32 v24, v16 offset:2048
    ds_read_b32 v25, v16 offset:4096
    ds_read_b32 v26, v16 offset:6144
    ds_read_b32 v27, v16 offset:8192
    s_waitcnt lgkmcnt(0)
    v_add_f32 v20, v20, v21
    v_add_f32 v22, v22, v23
    v_add_f32 v20, v20, v22
    v_add_f32 v24, v24, v25
    v_add_f32 v26, v26, v27
    v_add_f32 v24, v24, v26
    v_cvt_pk_bf16_f32 v20, v20, v20
    v_cvt_pk_bf16_f32 v24, v24, v24
    v_lshrrev_b32 v17, 7, v0
    v_bfe_u32 v18, v0, 5, 2
    v_bfe_u32 v19, v0, 2, 3
    v_and_b32 v21, 3, v0
    v_lshlrev_b32 v18, 5, v18
    v_lshl_add_u32 v18, v21, 3, v18
    v_add_u32 v18, v18, v19
    v_lshl_add_u32 v18, v17, 7, v18
    v_lshlrev_b32 v18, 1, v18
    ds_write_b16 v18, v20 offset:9216
    ds_write_b16 v18, v24 offset:9728
    s_waitcnt lgkmcnt(0)
    s_barrier
    v_mov_b32 v64, 0
    v_mov_b32 v65, 0
    v_mov_b32 v66, 0
    v_mov_b32 v67, 0
    v_mov_b32 v68, 0
    v_mov_b32 v69, 0
    v_mov_b32 v70, 0
    v_mov_b32 v71, 0
    v_mov_b32 v72, 0
    v_mov_b32 v73, 0
    v_mov_b32 v74, 0
    v_mov_b32 v75, 0
    v_mov_b32 v76, 0
    v_mov_b32 v77, 0
    v_mov_b32 v78, 0
    v_mov_b32 v79, 0
    v_lshlrev_b32 v15, 8, v3
    v_lshl_add_u32 v15, v2, 4, v15
    v_cmp_gt_u32 vcc, 4, v3
    s_and_saveexec_b64 s[40:41], vcc
    ds_read_b128 v[64:67], v15 offset:9216
    ds_read_b128 v[68:71], v15 offset:9280
    ds_read_b128 v[72:75], v15 offset:9344
    ds_read_b128 v[76:79], v15 offset:9408
    s_mov_b64 exec, s[40:41]
    s_waitcnt lgkmcnt(0) vmcnt(0)
    v_perm_b32 v24, v132, v128, s30
    v_perm_b32 v25, v140, v136, s30
    v_perm_b32 v26, v148, v144, s30
    v_perm_b32 v27, v156, v152, s30
    s_nop 1
    v_mfma_f32_16x16x32_bf16 v[32:35], v[24:27], v[64:67], 0
    v_perm_b32 v28, v132, v128, s31
    v_perm_b32 v29, v140, v136, s31
    v_perm_b32 v30, v148, v144, s31
    v_perm_b32 v31, v156, v152, s31
    s_nop 1
    v_mfma_f32_16x16x32_bf16 v[36:39], v[28:31], v[64:67], 0
    v_perm_b32 v24, v133, v129, s30
    v_perm_b32 v25, v141, v137, s30
    v_perm_b32 v26, v149, v145, s30
    v_perm_b32 v27, v157, v153, s30
    s_nop 1
    v_mfma_f32_16x16x32_bf16 v[40:43], v[24:27], v[64:67], 0
    v_perm_b32 v28, v133, v129, s31
    v_perm_b32 v29, v141, v137, s31
    v_perm_b32 v30, v149, v145, s31
    v_perm_b32 v31, v157, v153, s31
    s_nop 1
    v_mfma_f32_16x16x32_bf16 v[44:47], v[28:31], v[64:67], 0
    v_perm_b32 v24, v134, v130, s30
    v_perm_b32 v25, v142, v138, s30
    v_perm_b32 v26, v150, v146, s30
    v_perm_b32 v27, v158, v154, s30
    s_nop 1
    v_mfma_f32_16x16x32_bf16 v[48:51], v[24:27], v[64:67], 0
    v_perm_b32 v28, v134, v130, s31
    v_perm_b32 v29, v142, v138, s31
    v_perm_b32 v30, v150, v146, s31
    v_perm_b32 v31, v158, v154, s31
    s_nop 1
    v_mfma_f32_16x16x32_bf16 v[52:55], v[28:31], v[64:67], 0
    v_perm_b32 v24, v135, v131, s30
    v_perm_b32 v25, v143, v139, s30
    v_perm_b32 v26, v151, v147, s30
    v_perm_b32 v27, v159, v155, s30
    s_nop 1
    v_mfma_f32_16x16x32_bf16 v[56:59], v[24:27], v[64:67], 0
    v_perm_b32 v28, v135, v131, s31
    v_perm_b32 v29, v143, v139, s31
    v_perm_b32 v30, v151, v147, s31
    v_perm_b32 v31, v159, v155, s31
    s_nop 1
    v_mfma_f32_16x16x32_bf16 v[60:63], v[28:31], v[64:67], 0
    v_perm_b32 v24, v164, v160, s30
    v_perm_b32 v25, v172, v168, s30
    v_perm_b32 v26, v180, v176, s30
    v_perm_b32 v27, v188, v184, s30
    s_nop 1
    v_mfma_f32_16x16x32_bf16 v[32:35], v[24:27], v[68:71], v[32:35]
    v_perm_b32 v28, v164, v160, s31
    v_perm_b32 v29, v172, v168, s31
    v_perm_b32 v30, v180, v176, s31
    v_perm_b32 v31, v188, v184, s31
    s_nop 1
    v_mfma_f32_16x16x32_bf16 v[36:39], v[28:31], v[68:71], v[36:39]
    v_perm_b32 v24, v165, v161, s30
    v_perm_b32 v25, v173, v169, s30
    v_perm_b32 v26, v181, v177, s30
    v_perm_b32 v27, v189, v185, s30
    s_nop 1
    v_mfma_f32_16x16x32_bf16 v[40:43], v[24:27], v[68:71], v[40:43]
    v_perm_b32 v28, v165, v161, s31
    v_perm_b32 v29, v173, v169, s31
    v_perm_b32 v30, v181, v177, s31
    v_perm_b32 v31, v189, v185, s31
    s_nop 1
    v_mfma_f32_16x16x32_bf16 v[44:47], v[28:31], v[68:71], v[44:47]
    v_perm_b32 v24, v166, v162, s30
    v_perm_b32 v25, v174, v170, s30
    v_perm_b32 v26, v182, v178, s30
    v_perm_b32 v27, v190, v186, s30
    s_nop 1
    v_mfma_f32_16x16x32_bf16 v[48:51], v[24:27], v[68:71], v[48:51]
    v_perm_b32 v28, v166, v162, s31
    v_perm_b32 v29, v174, v170, s31
    v_perm_b32 v30, v182, v178, s31
    v_perm_b32 v31, v190, v186, s31
    s_nop 1
    v_mfma_f32_16x16x32_bf16 v[52:55], v[28:31], v[68:71], v[52:55]
    v_perm_b32 v24, v167, v163, s30
    v_perm_b32 v25, v175, v171, s30
    v_perm_b32 v26, v183, v179, s30
    v_perm_b32 v27, v191, v187, s30
    s_nop 1
    v_mfma_f32_16x16x32_bf16 v[56:59], v[24:27], v[68:71], v[56:59]
    v_perm_b32 v28, v167, v163, s31
    v_perm_b32 v29, v175, v171, s31
    v_perm_b32 v30, v183, v179, s31
    v_perm_b32 v31, v191, v187, s31
    s_nop 1
    v_mfma_f32_16x16x32_bf16 v[60:63], v[28:31], v[68:71], v[60:63]
    v_perm_b32 v24, v196, v192, s30
    v_perm_b32 v25, v204, v200, s30
    v_perm_b32 v26, v212, v208, s30
    v_perm_b32 v27, v220, v216, s30
    s_nop 1
    v_mfma_f32_16x16x32_bf16 v[32:35], v[24:27], v[72:75], v[32:35]
    v_perm_b32 v28, v196, v192, s31
    v_perm_b32 v29, v204, v200, s31
    v_perm_b32 v30, v212, v208, s31
    v_perm_b32 v31, v220, v216, s31
    s_nop 1
    v_mfma_f32_16x16x32_bf16 v[36:39], v[28:31], v[72:75], v[36:39]
    v_perm_b32 v24, v197, v193, s30
    v_perm_b32 v25, v205, v201, s30
    v_perm_b32 v26, v213, v209, s30
    v_perm_b32 v27, v221, v217, s30
    s_nop 1
    v_mfma_f32_16x16x32_bf16 v[40:43], v[24:27], v[72:75], v[40:43]
    v_perm_b32 v28, v197, v193, s31
    v_perm_b32 v29, v205, v201, s31
    v_perm_b32 v30, v213, v209, s31
    v_perm_b32 v31, v221, v217, s31
    s_nop 1
    v_mfma_f32_16x16x32_bf16 v[44:47], v[28:31], v[72:75], v[44:47]
    v_perm_b32 v24, v198, v194, s30
    v_perm_b32 v25, v206, v202, s30
    v_perm_b32 v26, v214, v210, s30
    v_perm_b32 v27, v222, v218, s30
    s_nop 1
    v_mfma_f32_16x16x32_bf16 v[48:51], v[24:27], v[72:75], v[48:51]
    v_perm_b32 v28, v198, v194, s31
    v_perm_b32 v29, v206, v202, s31
    v_perm_b32 v30, v214, v210, s31
    v_perm_b32 v31, v222, v218, s31
    s_nop 1
    v_mfma_f32_16x16x32_bf16 v[52:55], v[28:31], v[72:75], v[52:55]
    v_perm_b32 v24, v199, v195, s30
    v_perm_b32 v25, v207, v203, s30
    v_perm_b32 v26, v215, v211, s30
    v_perm_b32 v27, v223, v219, s30
    s_nop 1
    v_mfma_f32_16x16x32_bf16 v[56:59], v[24:27], v[72:75], v[56:59]
    v_perm_b32 v28, v199, v195, s31
    v_perm_b32 v29, v207, v203, s31
    v_perm_b32 v30, v215, v211, s31
    v_perm_b32 v31, v223, v219, s31
    s_nop 1
    v_mfma_f32_16x16x32_bf16 v[60:63], v[28:31], v[72:75], v[60:63]
    v_perm_b32 v24, v228, v224, s30
    v_perm_b32 v25, v236, v232, s30
    v_perm_b32 v26, v244, v240, s30
    v_perm_b32 v27, v252, v248, s30
    s_nop 1
    v_mfma_f32_16x16x32_bf16 v[32:35], v[24:27], v[76:79], v[32:35]
    v_perm_b32 v28, v228, v224, s31
    v_perm_b32 v29, v236, v232, s31
    v_perm_b32 v30, v244, v240, s31
    v_perm_b32 v31, v252, v248, s31
    s_nop 1
    v_mfma_f32_16x16x32_bf16 v[36:39], v[28:31], v[76:79], v[36:39]
    v_perm_b32 v24, v229, v225, s30
    v_perm_b32 v25, v237, v233, s30
    v_perm_b32 v26, v245, v241, s30
    v_perm_b32 v27, v253, v249, s30
    s_nop 1
    v_mfma_f32_16x16x32_bf16 v[40:43], v[24:27], v[76:79], v[40:43]
    v_perm_b32 v28, v229, v225, s31
    v_perm_b32 v29, v237, v233, s31
    v_perm_b32 v30, v245, v241, s31
    v_perm_b32 v31, v253, v249, s31
    s_nop 1
    v_mfma_f32_16x16x32_bf16 v[44:47], v[28:31], v[76:79], v[44:47]
    v_perm_b32 v24, v230, v226, s30
    v_perm_b32 v25, v238, v234, s30
    v_perm_b32 v26, v246, v242, s30
    v_perm_b32 v27, v254, v250, s30
    s_nop 1
    v_mfma_f32_16x16x32_bf16 v[48:51], v[24:27], v[76:79], v[48:51]
    v_perm_b32 v28, v230, v226, s31
    v_perm_b32 v29, v238, v234, s31
    v_perm_b32 v30, v246, v242, s31
    v_perm_b32 v31, v254, v250, s31
    s_nop 1
    v_mfma_f32_16x16x32_bf16 v[52:55], v[28:31], v[76:79], v[52:55]
    v_perm_b32 v24, v231, v227, s30
    v_perm_b32 v25, v239, v235, s30
    v_perm_b32 v26, v247, v243, s30
    v_perm_b32 v27, v255, v251, s30
    s_nop 1
    v_mfma_f32_16x16x32_bf16 v[56:59], v[24:27], v[76:79], v[56:59]
    v_perm_b32 v28, v231, v227, s31
    v_perm_b32 v29, v239, v235, s31
    v_perm_b32 v30, v247, v243, s31
    v_perm_b32 v31, v255, v251, s31
    s_nop 1
    v_mfma_f32_16x16x32_bf16 v[60:63], v[28:31], v[76:79], v[60:63]
    s_nop 7
    s_nop 3
    v_lshlrev_b32 v15, 11, v3
    v_lshl_add_u32 v15, v2, 7, v15
    s_lshl_b32 s38, s35, 13
    s_lshl_b32 s39, s29, 9
    s_add_u32 s38, s38, s39
    s_add_u32 s38, s38, 0xb00000
    v_cmp_gt_u32 vcc, 4, v3
    s_and_saveexec_b64 s[40:41], vcc
    buffer_store_dwordx4 v[32:35], v15, s[24:27], s38 offen offset:0
    buffer_store_dwordx4 v[36:39], v15, s[24:27], s38 offen offset:16
    buffer_store_dwordx4 v[40:43], v15, s[24:27], s38 offen offset:32
    buffer_store_dwordx4 v[44:47], v15, s[24:27], s38 offen offset:48
    buffer_store_dwordx4 v[48:51], v15, s[24:27], s38 offen offset:64
    buffer_store_dwordx4 v[52:55], v15, s[24:27], s38 offen offset:80
    buffer_store_dwordx4 v[56:59], v15, s[24:27], s38 offen offset:96
    buffer_store_dwordx4 v[60:63], v15, s[24:27], s38 offen offset:112
    s_endpgm
Lk3_end:
    s_endpgm
.p2align 8
.type k4_kernel,@function
k4_kernel:
    s_cmp_ge_u32 s2, 40
    s_cbranch_scc1 Lk4_end
    s_load_dwordx2 s[10:11], s[0:1], 104
    s_load_dwordx2 s[8:9], s[0:1], 88
    s_waitcnt lgkmcnt(0)
    s_mov_b32 s24, s10
    s_mov_b32 s25, s11
    s_mov_b32 s26, 0x10000000
    s_mov_b32 s27, 0x00020000
    s_mov_b32 s20, s8
    s_mov_b32 s21, s9
    s_mov_b32 s22, 0x2000
    s_mov_b32 s23, 0x00020000
    s_cmp_ge_u32 s2, 8
    s_cbranch_scc1 Lk4_b
    s_lshl_b32 s3, s2, 8
    v_add_u32 v1, s3, v0
    v_lshrrev_b32 v2, 9, v1
    v_and_b32 v3, 511, v1
    v_and_b32 v4, 7, v3
    v_bfe_u32 v5, v3, 3, 2
    v_bfe_u32 v6, v3, 5, 2
    v_lshlrev_b32 v6, 5, v6
    v_lshl_add_u32 v6, v4, 2, v6
    v_add_u32 v6, v6, v5
    v_lshrrev_b32 v7, 7, v3
    v_lshlrev_b32 v7, 11, v7
    v_lshl_add_u32 v7, v2, 9, v7
    v_lshl_add_u32 v7, v6, 2, v7
    s_mov_b32 s30, 0xa00000
    buffer_load_dword v16, v7, s[24:27], s30 offen
    s_add_u32 s30, s30, 8192
    buffer_load_dword v17, v7, s[24:27], s30 offen
    s_add_u32 s30, s30, 8192
    buffer_load_dword v18, v7, s[24:27], s30 offen
    s_add_u32 s30, s30, 8192
    buffer_load_dword v19, v7, s[24:27], s30 offen
    s_add_u32 s30, s30, 8192
    buffer_load_dword v20, v7, s[24:27], s30 offen
    s_add_u32 s30, s30, 8192
    buffer_load_dword v21, v7, s[24:27], s30 offen
    s_add_u32 s30, s30, 8192
    buffer_load_dword v22, v7, s[24:27], s30 offen
    s_add_u32 s30, s30, 8192
    buffer_load_dword v23, v7, s[24:27], s30 offen
    s_add_u32 s30, s30, 8192
    buffer_load_dword v24, v7, s[24:27], s30 offen
    s_add_u32 s30, s30, 8192
    buffer_load_dword v25, v7, s[24:27], s30 offen
    s_add_u32 s30, s30, 8192
    buffer_load_dword v26, v7, s[24:27], s30 offen
    s_add_u32 s30, s30, 8192
    buffer_load_dword v27, v7, s[24:27], s30 offen
    s_add_u32 s30, s30, 8192
    buffer_load_dword v28, v7, s[24:27], s30 offen
    s_add_u32 s30, s30, 8192
    buffer_load_dword v29, v7, s[24:27], s30 offen
    s_add_u32 s30, s30, 8192
    buffer_load_dword v30, v7, s[24:27], s30 offen
    s_add_u32 s30, s30, 8192
    buffer_load_dword v31, v7, s[24:27], s30 offen
    s_add_u32 s30, s30, 8192
    buffer_load_dword v32, v7, s[24:27], s30 offen
    s_add_u32 s30, s30, 8192
    buffer_load_dword v33, v7, s[24:27], s30 offen
    s_add_u32 s30, s30, 8192
    buffer_load_dword v34, v7, s[24:27], s30 offen
    s_add_u32 s30, s30, 8192
    buffer_load_dword v35, v7, s[24:27], s30 offen
    s_add_u32 s30, s30, 8192
    buffer_load_dword v36, v7, s[24:27], s30 offen
    s_add_u32 s30, s30, 8192
    buffer_load_dword v37, v7, s[24:27], s30 offen
    s_add_u32 s30, s30, 8192
    buffer_load_dword v38, v7, s[24:27], s30 offen
    s_add_u32 s30, s30, 8192
    buffer_load_dword v39, v7, s[24:27], s30 offen
    s_add_u32 s30, s30, 8192
    buffer_load_dword v40, v7, s[24:27], s30 offen
    s_add_u32 s30, s30, 8192
    buffer_load_dword v41, v7, s[24:27], s30 offen
    s_add_u32 s30, s30, 8192
    buffer_load_dword v42, v7, s[24:27], s30 offen
    s_add_u32 s30, s30, 8192
    buffer_load_dword v43, v7, s[24:27], s30 offen
    s_add_u32 s30, s30, 8192
    buffer_load_dword v44, v7, s[24:27], s30 offen
    s_add_u32 s30, s30, 8192
    buffer_load_dword v45, v7, s[24:27], s30 offen
    s_add_u32 s30, s30, 8192
    buffer_load_dword v46, v7, s[24:27], s30 offen
    s_add_u32 s30, s30, 8192
    buffer_load_dword v47, v7, s[24:27], s30 offen
    s_waitcnt vmcnt(0)
    v_add_f32 v16, v16, v17
    v_add_f32 v16, v16, v18
    v_add_f32 v16, v16, v19
    v_add_f32 v16, v16, v20
    v_add_f32 v16, v16, v21
    v_add_f32 v16, v16, v22
    v_add_f32 v16, v16, v23
    v_add_f32 v16, v16, v24
    v_add_f32 v16, v16, v25
    v_add_f32 v16, v16, v26
    v_add_f32 v16, v16, v27
    v_add_f32 v16, v16, v28
    v_add_f32 v16, v16, v29
    v_add_f32 v16, v16, v30
    v_add_f32 v16, v16, v31
    v_add_f32 v16, v16, v32
    v_add_f32 v16, v16, v33
    v_add_f32 v16, v16, v34
    v_add_f32 v16, v16, v35
    v_add_f32 v16, v16, v36
    v_add_f32 v16, v16, v37
    v_add_f32 v16, v16, v38
    v_add_f32 v16, v16, v39
    v_add_f32 v16, v16, v40
    v_add_f32 v16, v16, v41
    v_add_f32 v16, v16, v42
    v_add_f32 v16, v16, v43
    v_add_f32 v16, v16, v44
    v_add_f32 v16, v16, v45
    v_add_f32 v16, v16, v46
    v_add_f32 v16, v16, v47
    v_cvt_pk_bf16_f32 v16, v16, v16
    v_lshlrev_b32 v2, 10, v2
    v_add_u32 v2, v2, v3
    v_lshlrev_b32 v2, 1, v2
    buffer_store_short v16, v2, s[20:23], 0 offen
    s_endpgm
Lk4_b:
    s_sub_u32 s3, s2, 8
    s_lshl_b32 s3, s3, 6
    v_and_b32 v1, 63, v0
    v_add_u32 v1, s3, v1
    v_lshrrev_b32 v8, 6, v0
    v_lshrrev_b32 v2, 9, v1
    v_and_b32 v3, 511, v1
    v_and_b32 v4, 7, v3
    v_bfe_u32 v5, v3, 3, 2
    v_bfe_u32 v6, v3, 5, 2
    v_lshlrev_b32 v6, 5, v6
    v_lshl_add_u32 v6, v4, 2, v6
    v_add_u32 v6, v6, v5
    v_lshrrev_b32 v7, 7, v3
    v_lshl_add_u32 v6, v7, 7, v6
    v_lshlrev_b32 v7, 11, v2
    v_lshl_add_u32 v7, v6, 2, v7
    v_lshl_add_u32 v7, v8, 18, v7
    s_mov_b32 s30, 0xb00000
    buffer_load_dword v16, v7, s[24:27], s30 offen
    s_add_u32 s30, s30, 8192
    buffer_load_dword v17, v7, s[24:27], s30 offen
    s_add_u32 s30, s30, 8192
    buffer_load_dword v18, v7, s[24:27], s30 offen
    s_add_u32 s30, s30, 8192
    buffer_load_dword v19, v7, s[24:27], s30 offen
    s_add_u32 s30, s30, 8192
    buffer_load_dword v20, v7, s[24:27], s30 offen
    s_add_u32 s30, s30, 8192
    buffer_load_dword v21, v7, s[24:27], s30 offen
    s_add_u32 s30, s30, 8192
    buffer_load_dword v22, v7, s[24:27], s30 offen
    s_add_u32 s30, s30, 8192
    buffer_load_dword v23, v7, s[24:27], s30 offen
    s_add_u32 s30, s30, 8192
    buffer_load_dword v24, v7, s[24:27], s30 offen
    s_add_u32 s30, s30, 8192
    buffer_load_dword v25, v7, s[24:27], s30 offen
    s_add_u32 s30, s30, 8192
    buffer_load_dword v26, v7, s[24:27], s30 offen
    s_add_u32 s30, s30, 8192
    buffer_load_dword v27, v7, s[24:27], s30 offen
    s_add_u32 s30, s30, 8192
    buffer_load_dword v28, v7, s[24:27], s30 offen
    s_add_u32 s30, s30, 8192
    buffer_load_dword v29, v7, s[24:27], s30 offen
    s_add_u32 s30, s30, 8192
    buffer_load_dword v30, v7, s[24:27], s30 offen
    s_add_u32 s30, s30, 8192
    buffer_load_dword v31, v7, s[24:27], s30 offen
    s_add_u32 s30, s30, 8192
    buffer_load_dword v32, v7, s[24:27], s30 offen
    s_add_u32 s30, s30, 8192
    buffer_load_dword v33, v7, s[24:27], s30 offen
    s_add_u32 s30, s30, 8192
    buffer_load_dword v34, v7, s[24:27], s30 offen
    s_add_u32 s30, s30, 8192
    buffer_load_dword v35, v7, s[24:27], s30 offen
    s_add_u32 s30, s30, 8192
    buffer_load_dword v36, v7, s[24:27], s30 offen
    s_add_u32 s30, s30, 8192
    buffer_load_dword v37, v7, s[24:27], s30 offen
    s_add_u32 s30, s30, 8192
    buffer_load_dword v38, v7, s[24:27], s30 offen
    s_add_u32 s30, s30, 8192
    buffer_load_dword v39, v7, s[24:27], s30 offen
    s_add_u32 s30, s30, 8192
    buffer_load_dword v40, v7, s[24:27], s30 offen
    s_add_u32 s30, s30, 8192
    buffer_load_dword v41, v7, s[24:27], s30 offen
    s_add_u32 s30, s30, 8192
    buffer_load_dword v42, v7, s[24:27], s30 offen
    s_add_u32 s30, s30, 8192
    buffer_load_dword v43, v7, s[24:27], s30 offen
    s_add_u32 s30, s30, 8192
    buffer_load_dword v44, v7, s[24:27], s30 offen
    s_add_u32 s30, s30, 8192
    buffer_load_dword v45, v7, s[24:27], s30 offen
    s_add_u32 s30, s30, 8192
    buffer_load_dword v46, v7, s[24:27], s30 offen
    s_add_u32 s30, s30, 8192
    buffer_load_dword v47, v7, s[24:27], s30 offen
    s_waitcnt vmcnt(0)
    v_add_f32 v16, v16, v17
    v_add_f32 v16, v16, v18
    v_add_f32 v16, v16, v19
    v_add_f32 v16, v16, v20
    v_add_f32 v16, v16, v21
    v_add_f32 v16, v16, v22
    v_add_f32 v16, v16, v23
    v_add_f32 v16, v16, v24
    v_add_f32 v16, v16, v25
    v_add_f32 v16, v16, v26
    v_add_f32 v16, v16, v27
    v_add_f32 v16, v16, v28
    v_add_f32 v16, v16, v29
    v_add_f32 v16, v16, v30
    v_add_f32 v16, v16, v31
    v_add_f32 v16, v16, v32
    v_add_f32 v16, v16, v33
    v_add_f32 v16, v16, v34
    v_add_f32 v16, v16, v35
    v_add_f32 v16, v16, v36
    v_add_f32 v16, v16, v37
    v_add_f32 v16, v16, v38
    v_add_f32 v16, v16, v39
    v_add_f32 v16, v16, v40
    v_add_f32 v16, v16, v41
    v_add_f32 v16, v16, v42
    v_add_f32 v16, v16, v43
    v_add_f32 v16, v16, v44
    v_add_f32 v16, v16, v45
    v_add_f32 v16, v16, v46
    v_add_f32 v16, v16, v47
    v_lshlrev_b32 v9, 2, v0
    ds_write_b32 v9, v16
    s_waitcnt lgkmcnt(0)
    s_barrier
    v_cmp_gt_u32 vcc, 64, v0
    s_and_saveexec_b64 s[40:41], vcc
    ds_read_b32 v17, v9 offset:256
    ds_read_b32 v18, v9 offset:512
    ds_read_b32 v19, v9 offset:768
    s_waitcnt lgkmcnt(0)
    v_add_f32 v16, v16, v17
    v_add_f32 v18, v18, v19
    v_add_f32 v16, v16, v18
    v_cvt_pk_bf16_f32 v16, v16, v16
    v_lshlrev_b32 v2, 10, v2
    v_add_u32 v2, v2, v3
    v_add_u32 v2, 512, v2
    v_lshlrev_b32 v2, 1, v2
    buffer_store_short v16, v2, s[20:23], 0 offen
Lk4_end:
    s_endpgm
.section .rodata,"a"
.p2align 6
.amdhsa_kernel k1_kernel
  .amdhsa_next_free_vgpr 128
  .amdhsa_next_free_sgpr 102
  .amdhsa_accum_offset 128
  .amdhsa_group_segment_fixed_size 0
  .amdhsa_kernarg_size 112
  .amdhsa_user_sgpr_count 2
  .amdhsa_user_sgpr_kernarg_segment_ptr 1
  .amdhsa_system_sgpr_workgroup_id_x 1
.end_amdhsa_kernel
.amdhsa_kernel k2_kernel
  .amdhsa_next_free_vgpr 512
  .amdhsa_next_free_sgpr 102
  .amdhsa_accum_offset 256
  .amdhsa_group_segment_fixed_size 0
  .amdhsa_kernarg_size 112
  .amdhsa_user_sgpr_count 2
  .amdhsa_user_sgpr_kernarg_segment_ptr 1
  .amdhsa_system_sgpr_workgroup_id_x 1
.end_amdhsa_kernel
.amdhsa_kernel k3_kernel
  .amdhsa_next_free_vgpr 256
  .amdhsa_next_free_sgpr 102
  .amdhsa_accum_offset 256
  .amdhsa_group_segment_fixed_size 0
  .amdhsa_kernarg_size 112
  .amdhsa_user_sgpr_count 2
  .amdhsa_user_sgpr_kernarg_segment_ptr 1
  .amdhsa_system_sgpr_workgroup_id_x 1
.end_amdhsa_kernel
.amdhsa_kernel k4_kernel
  .amdhsa_next_free_vgpr 48
  .amdhsa_next_free_sgpr 102
  .amdhsa_accum_offset 48
  .amdhsa_group_segment_fixed_size 0
  .amdhsa_kernarg_size 112
  .amdhsa_user_sgpr_count 2
  .amdhsa_user_sgpr_kernarg_segment_ptr 1
  .amdhsa_system_sgpr_workgroup_id_x 1
.end_amdhsa_kernel
```
